```python
import torch

def _softmax(x, axis=-1):
    return torch.softmax(x, dim=axis)
def _gelu(x):
    return torch.nn.functional.gelu(x, approximate="tanh")
def _silu(x):
    return torch.nn.functional.silu(x)
def _sigmoid(x):
    return torch.sigmoid(x)
def _layernorm(x, axis=-1, eps=1e-5):
    m = x.mean(dim=axis, keepdim=True)
    v = x.var(dim=axis, keepdim=True, unbiased=False)
    return (x - m) / torch.sqrt(v + eps)
def _scatter_add(tgt, idx, src, axis=0):
    return tgt.clone().index_add_(axis, idx, src)
def _segment_sum(src, seg, n):
    out = torch.zeros((n,) + src.shape[1:], dtype=src.dtype)
    return out.index_add_(0, seg, src)
def _pad(x, pw):
    flat = tuple(v for pair in reversed(pw) for v in pair)
    return torch.nn.functional.pad(x, flat)

kernel_name = 'parallel_sum__compressed_kv_cla__glu_gated_swiglu__decode'

def setup_inputs():

    _w = (lambda a: (lambda t: t.to(torch.bfloat16) if t.is_floating_point() else t)(torch.as_tensor(a)))
    def _A_setup():
        B, H, Sq, Sk, D, M = 4, 32, 1, 4096, 128, 576
        Dc = 4 * D
        return {
            "x": _w((lambda *s: torch.randn(*s, dtype=torch.bfloat16) * 0.05)(B, Sq, M)),
            "c_kv": _w((lambda *s: torch.randn(*s, dtype=torch.bfloat16) * 0.8)(B, Sk, Dc)),
            "w_q": _w((lambda *s: torch.randn(*s, dtype=torch.bfloat16) * 1.6)(M, H, D) * (M ** -0.5)),
            "w_uk": _w((lambda *s: torch.randn(*s, dtype=torch.bfloat16) * 1.6)(Dc, H, D) * (Dc ** -0.5)),
            "w_uv": _w((lambda *s: torch.randn(*s, dtype=torch.bfloat16) * 0.8)(Dc, H, D) * (Dc ** -0.5)),
            "w_o": _w((lambda *s: torch.randn(*s, dtype=torch.bfloat16) * 0.8)(H, D, M) * ((H * D) ** -0.5)),
        }
    _A_in = _A_setup()

    def _B_setup():
        B, S, D, F = 4, 1, 576, 4608
        return {
            "x": _w((lambda *s: torch.randn(*s, dtype=torch.bfloat16) * 0.05)(B, S, D)),
            "w1": _w((lambda *s: torch.randn(*s, dtype=torch.bfloat16) * 0.4)(D, F) * (2.0 / D) ** 0.5),
            "w3": _w((lambda *s: torch.randn(*s, dtype=torch.bfloat16) * 0.4)(D, F) * (2.0 / D) ** 0.5),
            "w2": _w((lambda *s: torch.randn(*s, dtype=torch.bfloat16) * 0.4)(F, D) * (2.0 / F) ** 0.5),
        }
    _B_in = _B_setup()

    return {
        "A_x": _A_in["x"],
        "A_c_kv": _A_in["c_kv"],
        "A_w_q": _A_in["w_q"],
        "A_w_uk": _A_in["w_uk"],
        "A_w_uv": _A_in["w_uv"],
        "A_w_o": _A_in["w_o"],
        "B_x": _B_in["x"],
        "B_w1": _B_in["w1"],
        "B_w3": _B_in["w3"],
        "B_w2": _B_in["w2"],
    }

def reference(A_x, A_c_kv, A_w_q, A_w_uk, A_w_uv, A_w_o, B_x, B_w1, B_w3, B_w2):
    def _A_ref(x, c_kv, w_q, w_uk, w_uv, w_o):
        B, Sq, M = x.shape[0], x.shape[1], x.shape[2]
        Sk = c_kv.shape[1]
        H, D = w_q.shape[1], w_q.shape[2]
        q = torch.einsum("bqm,mhd->bhqd", x, w_q)
        k = torch.einsum("bkc,chd->bhkd", c_kv, w_uk)
        v = torch.einsum("bkc,chd->bhkd", c_kv, w_uv)
        scores = torch.einsum("bhqd,bhkd->bhqk", q, k) * (D ** -0.5)
        off = Sk - Sq
        qi = torch.arange(Sq)[:, None]
        kj = torch.arange(Sk)[None, :]
        cmask = kj <= (qi + off)
        scores = torch.where(cmask[None, None], scores, -1e9)
        p = _softmax(scores, axis=-1)
        ctx = torch.einsum("bhqk,bhkd->bhqd", p, v)
        return torch.einsum("bhqd,hdm->bqm", ctx, w_o)

    def _B_ref(x, w1, w3, w2):
        gate = torch.einsum("bsd,df->bsf", x, w1)
        up = torch.einsum("bsd,df->bsf", x, w3)
        h = _silu(gate) * up
        out = torch.einsum("bsf,fd->bsd", h, w2)
        return out

    x = A_x
    xn = _layernorm(x, axis=-1)
    return x + _A_ref(xn, A_c_kv, A_w_q, A_w_uk, A_w_uv, A_w_o) + _B_ref(xn, B_w1, B_w3, B_w2)
```

```asm
; @launch grid=(256,1,1) block=(256,1,1) lds=163840
.amdgcn_target "amdgcn-amd-amdhsa--gfx950"
.text
.globl parallel_sum__compressed_kv_cla__glu_gated_swiglu__decode_kernel
.p2align 8
.type parallel_sum__compressed_kv_cla__glu_gated_swiglu__decode_kernel,@function
parallel_sum__compressed_kv_cla__glu_gated_swiglu__decode_kernel:
    s_load_dwordx16 s[36:51], s[0:1], 0
    s_getpc_b64 s[66:67]
    s_load_dwordx8 s[52:59], s[0:1], 64
    s_load_dwordx2 s[64:65], s[0:1], 96
    s_cmp_ge_u32 s2, 256
    s_cbranch_scc1 L_end
    v_lshlrev_b32 v4, 6, v0
    s_cmp_ge_u32 s2, 128
    s_cselect_b32 s63, L_roleA-parallel_sum__compressed_kv_cla__glu_gated_swiglu__decode_kernel, 0
    v_add_u32 v4, s63, v4
    v_min_u32 v4, L_end-parallel_sum__compressed_kv_cla__glu_gated_swiglu__decode_kernel-32, v4
    global_load_dword v13, v4, s[66:67]
    v_lshrrev_b32 v4, 6, v0
    v_and_b32 v1, 63, v0
    v_readfirstlane_b32 s3, v4
    v_lshlrev_b32 v2, 4, v1
    s_and_b32 s61, s2, 7
    s_lshr_b32 s62, s2, 3
    v_lshrrev_b32 v16, 4, v1
    v_bfe_u32 v17, v1, 2, 2
    v_and_b32 v18, 3, v1
    v_and_b32 v19, 15, v1
    s_mov_b32 s6, 4608
    s_mov_b32 s7, 0x20000
    s_mul_i32 s63, s3, 1152
    v_lshlrev_b32 v7, 1, v1
    s_cmp_ge_u32 s62, 16
    s_cbranch_scc1 L_roleA
    s_lshl_b32 s61, s61, 2
    s_lshr_b32 s69, s62, 2
    s_add_u32 s61, s61, s69
    s_and_b32 s62, s62, 3
    s_mov_b32 s10, 4718592
    s_mov_b32 s11, 0x20000
    s_mul_i32 s69, s62, 5
    s_cmp_eq_u32 s62, 3
    s_cselect_b32 s66, 14, s69
    s_and_b32 s69, s3, 1
    s_lshl_b32 s69, s69, 2
    v_add_u32 v4, s69, v16
    v_lshlrev_b32 v4, 1, v4
    v_xor_b32 v4, v4, v19
    v_lshlrev_b32 v4, 4, v4
    v_lshl_add_u32 v20, v16, 13, v4
    s_lshl_b32 s68, s66, 18
    s_lshl_b32 s69, s3, 15
    s_add_u32 s68, s68, s69
    s_lshl_b32 s69, s61, 8
    s_add_u32 s68, s68, s69
    s_lshl_b32 s69, s3, 10
    s_add_u32 m0, s69, 8192
    s_waitcnt lgkmcnt(0)
    s_mov_b64 s[8:9], s[40:41]
    s_mov_b64 s[4:5], s[36:37]
    buffer_load_dwordx4 v[8:11], v2, s[4:7], s63 offen
    buffer_load_ushort v12, v7, s[4:7], s63 offen offset:1024
    s_load_dword s60, s[64:65], 0
    global_load_dword v13, v2, s[64:65] offset:64 sc1
    buffer_load_dwordx4 v20, s[8:11], s68 offen nt lds
    s_add_u32 m0, m0, 4096
    s_add_u32 s68, s68, 131072
    buffer_load_dwordx4 v20, s[8:11], s68 offen nt lds
    s_add_u32 m0, m0, 4096
    s_add_u32 s68, s68, 131072
    buffer_load_dwordx4 v20, s[8:11], s68 offen nt lds
    s_add_u32 m0, m0, 4096
    s_add_u32 s68, s68, 131072
    buffer_load_dwordx4 v20, s[8:11], s68 offen nt lds
    s_add_u32 m0, m0, 4096
    s_add_u32 s68, s68, 131072
    buffer_load_dwordx4 v20, s[8:11], s68 offen nt lds
    s_add_u32 m0, m0, 4096
    s_add_u32 s68, s68, 131072
    buffer_load_dwordx4 v20, s[8:11], s68 offen nt lds
    s_add_u32 m0, m0, 4096
    s_add_u32 s68, s68, 131072
    buffer_load_dwordx4 v20, s[8:11], s68 offen nt lds
    s_add_u32 m0, m0, 4096
    s_add_u32 s68, s68, 131072
    buffer_load_dwordx4 v20, s[8:11], s68 offen nt lds
    s_add_u32 m0, m0, 4096
    s_add_u32 s68, s68, 131072
    s_cmp_ge_u32 s62, 2
    s_cselect_b32 s68, 0x7f000000, s68
    buffer_load_dwordx4 v20, s[8:11], s68 offen nt lds
    s_add_u32 m0, m0, 4096
    s_add_u32 s68, s68, 131072
    buffer_load_dwordx4 v20, s[8:11], s68 offen nt lds
    s_mov_b64 s[12:13], s[42:43]
    s_mov_b32 s14, 4194304
    s_mov_b32 s15, 0x20000
    s_mov_b64 s[16:17], s[44:45]
    s_mov_b32 s18, 4194304
    s_mov_b32 s19, 0x20000
    s_mov_b64 s[20:21], s[50:51]
    s_mov_b32 s22, 5308416
    s_mov_b32 s23, 0x20000
    s_mov_b64 s[28:29], s[52:53]
    s_mov_b32 s30, 5308416
    s_mov_b32 s31, 0x20000
    s_mov_b64 s[24:25], s[64:65]
    s_mov_b32 s26, 9437184
    s_mov_b32 s27, 0x20000
    s_mov_b64 s[32:33], s[56:57]
    s_mov_b32 s34, 4608
    s_mov_b32 s35, 0x20000
    s_mov_b32 s67, 0xfff
    s_mov_b32 s68, 0xfffff000
    s_lshl_b32 s70, s61, 2
    s_add_u32 s70, s70, s62
    v_mul_u32_u24 v21, 1152, v18
    v_lshl_add_u32 v21, v16, 3, v21
    s_lshl_b32 s63, s66, 6
    v_add_u32 v21, s63, v21
    v_and_b32 v4, 1, v16
    v_lshl_add_u32 v4, v4, 2, v17
    v_lshlrev_b32 v26, 1, v4
    v_and_b32 v27, 1, v18
    v_lshlrev_b32 v27, 3, v27
    v_lshl_add_u32 v28, v16, 2, v17
    s_and_b32 s63, s3, 1
    s_lshl_b32 s63, s63, 3
    v_lshrrev_b32 v5, 1, v18
    v_add_u32 v5, s63, v5
    v_xor_b32 v4, v26, v5
    v_lshl_add_u32 v36, v4, 4, v27
    v_lshl_add_u32 v32, v28, 8, v36
    v_xor_b32 v33, 32, v32
    v_xor_b32 v34, 64, v32
    v_xor_b32 v35, 96, v32
    v_lshlrev_b32 v23, 6, v16
    v_lshl_add_u32 v23, v18, 4, v23
    v_lshl_add_u32 v37, v17, 28, v23
    v_lshlrev_b32 v24, 15, v18
    v_lshl_add_u32 v24, v16, 4, v24
    v_lshl_add_u32 v24, v17, 28, v24
    v_lshlrev_b32 v25, 11, v18
    v_lshl_add_u32 v25, v28, 26, v25
    s_lshl_b32 s56, s62, 20
    s_lshl_b32 s64, s3, 18
    s_add_u32 s56, s56, s64
    s_lshl_b32 s64, s61, 8
    s_add_u32 s56, s56, s64
    s_lshl_b32 s64, s3, 13
    s_add_u32 m0, s64, 49152
    v_xor_b32 v39, v16, v19
    v_lshlrev_b32 v39, 4, v39
    v_lshl_add_u32 v39, v16, 13, v39
    v_xor_b32 v38, 0, v39
    buffer_load_dwordx4 v38, s[12:15], s56 offen nt lds
    s_add_u32 m0, m0, 1024
    s_add_u32 s56, s56, 32768
    buffer_load_dwordx4 v38, s[12:15], s56 offen nt lds
    s_add_u32 m0, m0, 1024
    s_add_u32 s56, s56, 32768
    v_xor_b32 v38, 64, v39
    buffer_load_dwordx4 v38, s[12:15], s56 offen nt lds
    s_add_u32 m0, m0, 1024
    s_add_u32 s56, s56, 32768
    buffer_load_dwordx4 v38, s[12:15], s56 offen nt lds
    s_add_u32 m0, m0, 1024
    s_add_u32 s56, s56, 32768
    s_waitcnt vmcnt(15)
    v_lshlrev_b32 v40, 16, v8
    v_and_b32 v41, 0xffff0000, v8
    v_lshlrev_b32 v42, 16, v9
    v_and_b32 v43, 0xffff0000, v9
    v_lshlrev_b32 v44, 16, v10
    v_and_b32 v45, 0xffff0000, v10
    v_lshlrev_b32 v46, 16, v11
    v_and_b32 v47, 0xffff0000, v11
    v_lshlrev_b32 v48, 16, v12
    v_pk_add_f32 v[52:53], v[40:41], v[42:43]
    v_pk_add_f32 v[50:51], v[44:45], v[46:47]
    v_pk_add_f32 v[52:53], v[52:53], v[50:51]
    v_add_f32 v49, v52, v53
    v_add_f32 v49, v49, v48
    s_nop 1
    v_add_f32_dpp v49, v49, v49 quad_perm:[1,0,3,2] row_mask:0xf bank_mask:0xf
    s_nop 1
    v_add_f32_dpp v49, v49, v49 quad_perm:[2,3,0,1] row_mask:0xf bank_mask:0xf
    s_nop 1
    v_add_f32_dpp v49, v49, v49 row_half_mirror row_mask:0xf bank_mask:0xf
    s_nop 1
    v_add_f32_dpp v49, v49, v49 row_mirror row_mask:0xf bank_mask:0xf
    v_mov_b32 v50, v49
    s_nop 1
    v_permlane16_swap_b32 v49, v50
    v_add_f32 v49, v49, v50
    v_mov_b32 v50, v49
    s_nop 1
    v_permlane32_swap_b32 v49, v50
    v_add_f32 v49, v49, v50
    v_mul_f32 v51, 0.001736111111111111, v49
    v_sub_f32 v50, v40, v51
    v_mul_f32 v49, v50, v50
    v_sub_f32 v50, v41, v51
    v_fmac_f32 v49, v50, v50
    v_sub_f32 v50, v42, v51
    v_fmac_f32 v49, v50, v50
    v_sub_f32 v50, v43, v51
    v_fmac_f32 v49, v50, v50
    v_sub_f32 v50, v44, v51
    v_fmac_f32 v49, v50, v50
    v_sub_f32 v50, v45, v51
    v_fmac_f32 v49, v50, v50
    v_sub_f32 v50, v46, v51
    v_fmac_f32 v49, v50, v50
    v_sub_f32 v50, v47, v51
    v_fmac_f32 v49, v50, v50
    v_sub_f32 v50, v48, v51
    v_fmac_f32 v49, v50, v50
    s_nop 1
    v_add_f32_dpp v49, v49, v49 quad_perm:[1,0,3,2] row_mask:0xf bank_mask:0xf
    s_nop 1
    v_add_f32_dpp v49, v49, v49 quad_perm:[2,3,0,1] row_mask:0xf bank_mask:0xf
    s_nop 1
    v_add_f32_dpp v49, v49, v49 row_half_mirror row_mask:0xf bank_mask:0xf
    s_nop 1
    v_add_f32_dpp v49, v49, v49 row_mirror row_mask:0xf bank_mask:0xf
    v_mov_b32 v50, v49
    s_nop 1
    v_permlane16_swap_b32 v49, v50
    v_add_f32 v49, v49, v50
    v_mov_b32 v50, v49
    s_nop 1
    v_permlane32_swap_b32 v49, v50
    v_add_f32 v49, v49, v50
    v_mul_f32 v49, 0.001736111111111111, v49
    v_cvt_pk_bf16_f32 v49, v49, v49
    v_and_b32 v49, 0xffff0000, v49
    v_cvt_pk_bf16_f32 v51, v51, v51
    v_and_b32 v51, 0xffff0000, v51
    v_add_f32 v49, 1e-5, v49
    v_cvt_pk_bf16_f32 v49, v49, v49
    v_and_b32 v49, 0xffff0000, v49
    v_sqrt_f32 v49, v49
    v_sub_f32 v40, v40, v51
    v_sub_f32 v41, v41, v51
    v_sub_f32 v42, v42, v51
    v_sub_f32 v43, v43, v51
    v_sub_f32 v44, v44, v51
    v_sub_f32 v45, v45, v51
    v_sub_f32 v46, v46, v51
    v_sub_f32 v47, v47, v51
    v_sub_f32 v48, v48, v51
    v_cvt_pk_bf16_f32 v49, v49, v49
    v_and_b32 v49, 0xffff0000, v49
    v_rcp_f32 v49, v49
    v_cvt_pk_bf16_f32 v8, v40, v41
    v_cvt_pk_bf16_f32 v9, v42, v43
    v_cvt_pk_bf16_f32 v10, v44, v45
    v_cvt_pk_bf16_f32 v11, v46, v47
    v_cvt_pk_bf16_f32 v12, v48, v48
    v_lshlrev_b32 v40, 16, v8
    v_and_b32 v41, 0xffff0000, v8
    v_lshlrev_b32 v42, 16, v9
    v_and_b32 v43, 0xffff0000, v9
    v_lshlrev_b32 v44, 16, v10
    v_and_b32 v45, 0xffff0000, v10
    v_lshlrev_b32 v46, 16, v11
    v_and_b32 v47, 0xffff0000, v11
    v_lshlrev_b32 v48, 16, v12
    v_mul_f32 v40, v40, v49
    v_mul_f32 v41, v41, v49
    v_mul_f32 v42, v42, v49
    v_mul_f32 v43, v43, v49
    v_mul_f32 v44, v44, v49
    v_mul_f32 v45, v45, v49
    v_mul_f32 v46, v46, v49
    v_mul_f32 v47, v47, v49
    v_mul_f32 v48, v48, v49
    v_cvt_pk_bf16_f32 v8, v40, v41
    v_cvt_pk_bf16_f32 v9, v42, v43
    v_cvt_pk_bf16_f32 v10, v44, v45
    v_cvt_pk_bf16_f32 v11, v46, v47
    v_cvt_pk_bf16_f32 v12, v48, v48
    s_mul_i32 s63, s3, 1152
    s_add_u32 s63, s63, 0
    v_add_u32 v50, s63, v2
    v_lshl_add_u32 v51, v1, 1, s63
    ds_write_b128 v50, v[8:11]
    ds_write_b16 v51, v12 offset:1024
    v_xor_b32 v38, 128, v39
    buffer_load_dwordx4 v38, s[12:15], s56 offen nt lds
    s_add_u32 m0, m0, 1024
    s_add_u32 s56, s56, 32768
    buffer_load_dwordx4 v38, s[12:15], s56 offen nt lds
    s_add_u32 m0, m0, 1024
    s_add_u32 s56, s56, 32768
    v_xor_b32 v38, 192, v39
    buffer_load_dwordx4 v38, s[12:15], s56 offen nt lds
    s_add_u32 m0, m0, 1024
    s_add_u32 s56, s56, 32768
    buffer_load_dwordx4 v38, s[12:15], s56 offen nt lds
    s_waitcnt lgkmcnt(0)
    s_add_u32 s71, s60, 1
    s_and_b32 s60, s71, s67
    v_mov_b32 v3, s60
    s_lshl_b32 s52, s70, 11
    s_and_b32 s64, s3, 1
    s_lshl_b32 s64, s64, 10
    s_add_u32 s52, s52, s64
    s_add_u32 s52, s52, 262144
    s_lshl_b32 s54, s61, 13
    s_add_u32 s54, s54, s64
    s_add_u32 s54, s54, 262144
    v_lshl_add_u32 v56, v17, 11, v23
    s_lshr_b32 s64, s64, 1
    v_add_u32 v57, s64, v23
    s_waitcnt vmcnt(8) lgkmcnt(0)
    s_barrier
    s_cmp_ge_u32 s3, 2
    s_cbranch_scc1 L_e1p
    ds_read2_b64 v[144:147], v21 offset0:0 offset1:4
    ds_read_b64_tr_b16 v[164:165], v32 offset:8192
    ds_read_b64_tr_b16 v[166:167], v32 offset:12288
    ds_read_b64_tr_b16 v[168:169], v33 offset:8192
    ds_read_b64_tr_b16 v[170:171], v33 offset:12288
    ds_read_b64_tr_b16 v[172:173], v34 offset:8192
    ds_read_b64_tr_b16 v[174:175], v34 offset:12288
    ds_read_b64_tr_b16 v[176:177], v35 offset:8192
    ds_read_b64_tr_b16 v[178:179], v35 offset:12288
    ds_read2_b64 v[148:151], v21 offset0:8 offset1:12
    ds_read_b64_tr_b16 v[180:181], v32 offset:16384
    ds_read_b64_tr_b16 v[182:183], v32 offset:20480
    ds_read_b64_tr_b16 v[184:185], v33 offset:16384
    ds_read_b64_tr_b16 v[186:187], v33 offset:20480
    ds_read_b64_tr_b16 v[188:189], v34 offset:16384
    ds_read_b64_tr_b16 v[190:191], v34 offset:20480
    ds_read_b64_tr_b16 v[192:193], v35 offset:16384
    ds_read_b64_tr_b16 v[194:195], v35 offset:20480
    s_waitcnt lgkmcnt(9)
    v_mfma_f32_16x16x32_bf16 v[128:131], v[164:167], v[144:147], 0
    v_mfma_f32_16x16x32_bf16 v[132:135], v[168:171], v[144:147], 0
    v_mfma_f32_16x16x32_bf16 v[136:139], v[172:175], v[144:147], 0
    v_mfma_f32_16x16x32_bf16 v[140:143], v[176:179], v[144:147], 0
    ds_read2_b64 v[152:155], v21 offset0:16 offset1:20
    ds_read_b64_tr_b16 v[196:197], v32 offset:24576
    ds_read_b64_tr_b16 v[198:199], v32 offset:28672
    ds_read_b64_tr_b16 v[200:201], v33 offset:24576
    ds_read_b64_tr_b16 v[202:203], v33 offset:28672
    ds_read_b64_tr_b16 v[204:205], v34 offset:24576
    ds_read_b64_tr_b16 v[206:207], v34 offset:28672
    ds_read_b64_tr_b16 v[208:209], v35 offset:24576
    ds_read_b64_tr_b16 v[210:211], v35 offset:28672
    s_waitcnt lgkmcnt(9)
    v_mfma_f32_16x16x32_bf16 v[128:131], v[180:183], v[148:151], v[128:131]
    v_mfma_f32_16x16x32_bf16 v[132:135], v[184:187], v[148:151], v[132:135]
    v_mfma_f32_16x16x32_bf16 v[136:139], v[188:191], v[148:151], v[136:139]
    v_mfma_f32_16x16x32_bf16 v[140:143], v[192:195], v[148:151], v[140:143]
    ds_read2_b64 v[156:159], v21 offset0:24 offset1:28
    ds_read_b64_tr_b16 v[212:213], v32 offset:32768
    ds_read_b64_tr_b16 v[214:215], v32 offset:36864
    ds_read_b64_tr_b16 v[216:217], v33 offset:32768
    ds_read_b64_tr_b16 v[218:219], v33 offset:36864
    ds_read_b64_tr_b16 v[220:221], v34 offset:32768
    ds_read_b64_tr_b16 v[222:223], v34 offset:36864
    ds_read_b64_tr_b16 v[224:225], v35 offset:32768
    ds_read_b64_tr_b16 v[226:227], v35 offset:36864
    s_waitcnt lgkmcnt(9)
    v_mfma_f32_16x16x32_bf16 v[128:131], v[196:199], v[152:155], v[128:131]
    v_mfma_f32_16x16x32_bf16 v[132:135], v[200:203], v[152:155], v[132:135]
    v_mfma_f32_16x16x32_bf16 v[136:139], v[204:207], v[152:155], v[136:139]
    v_mfma_f32_16x16x32_bf16 v[140:143], v[208:211], v[152:155], v[140:143]
    ds_read2_b64 v[160:163], v21 offset0:32 offset1:36
    ds_read_b64_tr_b16 v[228:229], v32 offset:40960
    ds_read_b64_tr_b16 v[230:231], v32 offset:45056
    ds_read_b64_tr_b16 v[232:233], v33 offset:40960
    ds_read_b64_tr_b16 v[234:235], v33 offset:45056
    ds_read_b64_tr_b16 v[236:237], v34 offset:40960
    ds_read_b64_tr_b16 v[238:239], v34 offset:45056
    ds_read_b64_tr_b16 v[240:241], v35 offset:40960
    ds_read_b64_tr_b16 v[242:243], v35 offset:45056
    s_waitcnt lgkmcnt(9)
    v_mfma_f32_16x16x32_bf16 v[128:131], v[212:215], v[156:159], v[128:131]
    v_mfma_f32_16x16x32_bf16 v[132:135], v[216:219], v[156:159], v[132:135]
    v_mfma_f32_16x16x32_bf16 v[136:139], v[220:223], v[156:159], v[136:139]
    v_mfma_f32_16x16x32_bf16 v[140:143], v[224:227], v[156:159], v[140:143]
    s_waitcnt lgkmcnt(0)
    s_cmp_ge_u32 s62, 2
    s_nop 4
    s_cbranch_scc1 L_q_skip5
    v_mfma_f32_16x16x32_bf16 v[128:131], v[228:231], v[160:163], v[128:131]
    v_mfma_f32_16x16x32_bf16 v[132:135], v[232:235], v[160:163], v[132:135]
    v_mfma_f32_16x16x32_bf16 v[136:139], v[236:239], v[160:163], v[136:139]
    v_mfma_f32_16x16x32_bf16 v[140:143], v[240:243], v[160:163], v[140:143]
    s_nop 2
L_q_skip5:
    s_nop 2
    v_and_or_b32 v128, v128, s68, v3
    v_and_or_b32 v129, v129, s68, v3
    v_and_or_b32 v130, v130, s68, v3
    v_and_or_b32 v131, v131, s68, v3
    buffer_store_dwordx4 v[128:131], v37, s[24:27], s52 offen offset:0 sc1
    v_and_or_b32 v132, v132, s68, v3
    v_and_or_b32 v133, v133, s68, v3
    v_and_or_b32 v134, v134, s68, v3
    v_and_or_b32 v135, v135, s68, v3
    buffer_store_dwordx4 v[132:135], v37, s[24:27], s52 offen offset:256 sc1
    v_and_or_b32 v136, v136, s68, v3
    v_and_or_b32 v137, v137, s68, v3
    v_and_or_b32 v138, v138, s68, v3
    v_and_or_b32 v139, v139, s68, v3
    buffer_store_dwordx4 v[136:139], v37, s[24:27], s52 offen offset:512 sc1
    v_and_or_b32 v140, v140, s68, v3
    v_and_or_b32 v141, v141, s68, v3
    v_and_or_b32 v142, v142, s68, v3
    v_and_or_b32 v143, v143, s68, v3
    buffer_store_dwordx4 v[140:143], v37, s[24:27], s52 offen offset:768 sc1
    v_lshl_add_u32 v4, v17, 3, v18
    v_lshlrev_b32 v4, 8, v4
    s_lshl_b32 s64, s3, 13
    v_add_u32 v4, s64, v4
    v_and_b32 v5, 1, v16
    v_lshl_add_u32 v4, v5, 3, v4
    v_lshrrev_b32 v5, 1, v16
    v_xor_b32 v5, v5, v19
    v_xor_b32 v6, 0, v5
    v_lshl_add_u32 v108, v6, 4, v4
    v_xor_b32 v6, 2, v5
    v_lshl_add_u32 v109, v6, 4, v4
    v_xor_b32 v6, 4, v5
    v_lshl_add_u32 v110, v6, 4, v4
    v_xor_b32 v6, 6, v5
    v_lshl_add_u32 v111, v6, 4, v4
    v_xor_b32 v6, 8, v5
    v_lshl_add_u32 v112, v6, 4, v4
    v_xor_b32 v6, 10, v5
    v_lshl_add_u32 v113, v6, 4, v4
    v_xor_b32 v6, 12, v5
    v_lshl_add_u32 v114, v6, 4, v4
    v_xor_b32 v6, 14, v5
    v_lshl_add_u32 v115, v6, 4, v4
    s_lshl_b32 s63, s62, 2
    s_add_u32 s63, s63, s3
    s_lshl_b32 s63, s63, 11
    s_lshl_b32 s64, s61, 6
    s_add_u32 s63, s63, s64
    s_add_u32 s63, s63, 131072
    s_and_b32 s64, s61, 15
    s_lshl_b32 s56, s62, 4
    s_add_u32 s64, s64, s56
    s_lshl_b32 s64, s64, 3
    s_lshl_b32 s56, s3, 1
    s_add_u32 s64, s64, s56
    s_lshr_b32 s56, s61, 4
    s_add_u32 s64, s64, s56
    s_lshl_b32 s64, s64, 2
    s_add_u32 s64, s64, 4096
    s_waitcnt vmcnt(4)
    ds_read_b64 v[76:77], v108 offset:49152
    ds_read_b64 v[78:79], v109 offset:49152
    ds_read_b64 v[80:81], v108 offset:50176
    ds_read_b64 v[82:83], v109 offset:50176
    ds_read_b64 v[84:85], v110 offset:49152
    ds_read_b64 v[86:87], v111 offset:49152
    ds_read_b64 v[88:89], v110 offset:50176
    ds_read_b64 v[90:91], v111 offset:50176
    ds_read_b64 v[92:93], v112 offset:49152
    ds_read_b64 v[94:95], v113 offset:49152
    ds_read_b64 v[96:97], v112 offset:50176
    ds_read_b64 v[98:99], v113 offset:50176
    ds_read_b64 v[100:101], v114 offset:49152
    ds_read_b64 v[102:103], v115 offset:49152
    ds_read_b64 v[104:105], v114 offset:50176
    ds_read_b64 v[106:107], v115 offset:50176
    s_branch L_e1j
L_e1p:
    v_lshl_add_u32 v4, v17, 3, v18
    v_lshlrev_b32 v4, 8, v4
    s_lshl_b32 s64, s3, 13
    v_add_u32 v4, s64, v4
    v_and_b32 v5, 1, v16
    v_lshl_add_u32 v4, v5, 3, v4
    v_lshrrev_b32 v5, 1, v16
    v_xor_b32 v5, v5, v19
    v_xor_b32 v6, 0, v5
    v_lshl_add_u32 v108, v6, 4, v4
    v_xor_b32 v6, 2, v5
    v_lshl_add_u32 v109, v6, 4, v4
    v_xor_b32 v6, 4, v5
    v_lshl_add_u32 v110, v6, 4, v4
    v_xor_b32 v6, 6, v5
    v_lshl_add_u32 v111, v6, 4, v4
    v_xor_b32 v6, 8, v5
    v_lshl_add_u32 v112, v6, 4, v4
    v_xor_b32 v6, 10, v5
    v_lshl_add_u32 v113, v6, 4, v4
    v_xor_b32 v6, 12, v5
    v_lshl_add_u32 v114, v6, 4, v4
    v_xor_b32 v6, 14, v5
    v_lshl_add_u32 v115, v6, 4, v4
    s_lshl_b32 s63, s62, 2
    s_add_u32 s63, s63, s3
    s_lshl_b32 s63, s63, 11
    s_lshl_b32 s64, s61, 6
    s_add_u32 s63, s63, s64
    s_add_u32 s63, s63, 131072
    s_and_b32 s64, s61, 15
    s_lshl_b32 s56, s62, 4
    s_add_u32 s64, s64, s56
    s_lshl_b32 s64, s64, 3
    s_lshl_b32 s56, s3, 1
    s_add_u32 s64, s64, s56
    s_lshr_b32 s56, s61, 4
    s_add_u32 s64, s64, s56
    s_lshl_b32 s64, s64, 2
    s_add_u32 s64, s64, 4096
    s_waitcnt vmcnt(0)
    ds_read_b64 v[76:77], v108 offset:49152
    ds_read_b64 v[78:79], v109 offset:49152
    ds_read_b64 v[80:81], v108 offset:50176
    ds_read_b64 v[82:83], v109 offset:50176
    ds_read_b64 v[84:85], v110 offset:49152
    ds_read_b64 v[86:87], v111 offset:49152
    ds_read_b64 v[88:89], v110 offset:50176
    ds_read_b64 v[90:91], v111 offset:50176
    ds_read_b64 v[92:93], v112 offset:49152
    ds_read_b64 v[94:95], v113 offset:49152
    ds_read_b64 v[96:97], v112 offset:50176
    ds_read_b64 v[98:99], v113 offset:50176
    ds_read_b64 v[100:101], v114 offset:49152
    ds_read_b64 v[102:103], v115 offset:49152
    ds_read_b64 v[104:105], v114 offset:50176
    ds_read_b64 v[106:107], v115 offset:50176
    buffer_load_dwordx4 v[40:43], v56, s[24:27], s54 offen offset:0 sc1
    buffer_load_dwordx4 v[44:47], v56, s[24:27], s54 offen offset:256 sc1
    buffer_load_dwordx4 v[48:51], v56, s[24:27], s54 offen offset:512 sc1
    buffer_load_dwordx4 v[52:55], v56, s[24:27], s54 offen offset:768 sc1
    s_mov_b32 s69, 40000
Lq_1:
    s_waitcnt vmcnt(0)
    v_bitop3_b32 v124, v40, v41, v42 bitop3:0x7e
    v_bitop3_b32 v125, v40, v43, v3 bitop3:0x7e
    v_bitop3_b32 v124, v124, v125, s67 bitop3:0xa8
    v_cmp_ne_u32 s[36:37], 0, v124
    v_bitop3_b32 v124, v44, v45, v46 bitop3:0x7e
    v_bitop3_b32 v125, v44, v47, v3 bitop3:0x7e
    v_bitop3_b32 v124, v124, v125, s67 bitop3:0xa8
    v_cmp_ne_u32 s[38:39], 0, v124
    v_bitop3_b32 v124, v48, v49, v50 bitop3:0x7e
    v_bitop3_b32 v125, v48, v51, v3 bitop3:0x7e
    v_bitop3_b32 v124, v124, v125, s67 bitop3:0xa8
    v_cmp_ne_u32 s[40:41], 0, v124
    v_bitop3_b32 v124, v52, v53, v54 bitop3:0x7e
    v_bitop3_b32 v125, v52, v55, v3 bitop3:0x7e
    v_bitop3_b32 v124, v124, v125, s67 bitop3:0xa8
    v_cmp_ne_u32 s[42:43], 0, v124
    s_or_b64 vcc, s[36:37], s[38:39]
    s_or_b64 vcc, vcc, s[40:41]
    s_or_b64 vcc, vcc, s[42:43]
    s_nop 0
    s_cbranch_scc0 Lqd_2
    s_mov_b64 exec, s[36:37]
    buffer_load_dwordx4 v[40:43], v56, s[24:27], s54 offen offset:0 sc1
    s_mov_b64 exec, s[38:39]
    buffer_load_dwordx4 v[44:47], v56, s[24:27], s54 offen offset:256 sc1
    s_mov_b64 exec, s[40:41]
    buffer_load_dwordx4 v[48:51], v56, s[24:27], s54 offen offset:512 sc1
    s_mov_b64 exec, s[42:43]
    buffer_load_dwordx4 v[52:55], v56, s[24:27], s54 offen offset:768 sc1
    s_mov_b64 exec, -1
    s_sub_u32 s69, s69, 1
    s_cbranch_scc0 Lq_1
Lqd_2:
    v_xor_b32 v40, v3, v40
    v_xor_b32 v41, v3, v41
    v_xor_b32 v42, v3, v42
    v_xor_b32 v43, v3, v43
    v_xor_b32 v44, v3, v44
    v_xor_b32 v45, v3, v45
    v_xor_b32 v46, v3, v46
    v_xor_b32 v47, v3, v47
    v_xor_b32 v48, v3, v48
    v_xor_b32 v49, v3, v49
    v_xor_b32 v50, v3, v50
    v_xor_b32 v51, v3, v51
    v_xor_b32 v52, v3, v52
    v_xor_b32 v53, v3, v53
    v_xor_b32 v54, v3, v54
    v_xor_b32 v55, v3, v55
    v_add_f32_dpp v128, v40, v40 row_ror:4 row_mask:0xf bank_mask:0xf
    v_add_f32_dpp v129, v41, v41 row_ror:4 row_mask:0xf bank_mask:0xf
    v_add_f32_dpp v130, v42, v42 row_ror:4 row_mask:0xf bank_mask:0xf
    v_add_f32_dpp v131, v43, v43 row_ror:4 row_mask:0xf bank_mask:0xf
    v_add_f32_dpp v132, v44, v44 row_ror:4 row_mask:0xf bank_mask:0xf
    v_add_f32_dpp v133, v45, v45 row_ror:4 row_mask:0xf bank_mask:0xf
    v_add_f32_dpp v134, v46, v46 row_ror:4 row_mask:0xf bank_mask:0xf
    v_add_f32_dpp v135, v47, v47 row_ror:4 row_mask:0xf bank_mask:0xf
    v_add_f32_dpp v128, v128, v128 row_ror:8 row_mask:0xf bank_mask:0xf
    v_add_f32_dpp v129, v129, v129 row_ror:8 row_mask:0xf bank_mask:0xf
    v_add_f32_dpp v130, v130, v130 row_ror:8 row_mask:0xf bank_mask:0xf
    v_add_f32_dpp v131, v131, v131 row_ror:8 row_mask:0xf bank_mask:0xf
    v_add_f32_dpp v132, v132, v132 row_ror:8 row_mask:0xf bank_mask:0xf
    v_add_f32_dpp v133, v133, v133 row_ror:8 row_mask:0xf bank_mask:0xf
    v_add_f32_dpp v134, v134, v134 row_ror:8 row_mask:0xf bank_mask:0xf
    v_add_f32_dpp v135, v135, v135 row_ror:8 row_mask:0xf bank_mask:0xf
    v_cvt_pk_bf16_f32 v128, v128, v129
    v_cvt_pk_bf16_f32 v129, v130, v131
    v_cvt_pk_bf16_f32 v130, v132, v133
    v_cvt_pk_bf16_f32 v131, v134, v135
    ds_write_b128 v57, v[128:131] offset:4608
    v_add_f32_dpp v136, v48, v48 row_ror:4 row_mask:0xf bank_mask:0xf
    v_add_f32_dpp v137, v49, v49 row_ror:4 row_mask:0xf bank_mask:0xf
    v_add_f32_dpp v138, v50, v50 row_ror:4 row_mask:0xf bank_mask:0xf
    v_add_f32_dpp v139, v51, v51 row_ror:4 row_mask:0xf bank_mask:0xf
    v_add_f32_dpp v140, v52, v52 row_ror:4 row_mask:0xf bank_mask:0xf
    v_add_f32_dpp v141, v53, v53 row_ror:4 row_mask:0xf bank_mask:0xf
    v_add_f32_dpp v142, v54, v54 row_ror:4 row_mask:0xf bank_mask:0xf
    v_add_f32_dpp v143, v55, v55 row_ror:4 row_mask:0xf bank_mask:0xf
    v_add_f32_dpp v136, v136, v136 row_ror:8 row_mask:0xf bank_mask:0xf
    v_add_f32_dpp v137, v137, v137 row_ror:8 row_mask:0xf bank_mask:0xf
    v_add_f32_dpp v138, v138, v138 row_ror:8 row_mask:0xf bank_mask:0xf
    v_add_f32_dpp v139, v139, v139 row_ror:8 row_mask:0xf bank_mask:0xf
    v_add_f32_dpp v140, v140, v140 row_ror:8 row_mask:0xf bank_mask:0xf
    v_add_f32_dpp v141, v141, v141 row_ror:8 row_mask:0xf bank_mask:0xf
    v_add_f32_dpp v142, v142, v142 row_ror:8 row_mask:0xf bank_mask:0xf
    v_add_f32_dpp v143, v143, v143 row_ror:8 row_mask:0xf bank_mask:0xf
    v_cvt_pk_bf16_f32 v136, v136, v137
    v_cvt_pk_bf16_f32 v137, v138, v139
    v_cvt_pk_bf16_f32 v138, v140, v141
    v_cvt_pk_bf16_f32 v139, v142, v143
    ds_write_b128 v57, v[136:139] offset:4864
L_e1j:
    s_waitcnt lgkmcnt(0)
    s_barrier
    ds_read_b128 v[60:63], v23 offset:4608
    ds_read_b128 v[64:67], v23 offset:4864
    ds_read_b128 v[68:71], v23 offset:5120
    ds_read_b128 v[72:75], v23 offset:5376
    s_waitcnt lgkmcnt(3)
    v_mfma_f32_16x16x32_bf16 v[116:119], v[76:79], v[60:63], 0
    v_mfma_f32_16x16x32_bf16 v[120:123], v[80:83], v[60:63], 0
    s_waitcnt lgkmcnt(2)
    v_mfma_f32_16x16x32_bf16 v[116:119], v[84:87], v[64:67], v[116:119]
    v_mfma_f32_16x16x32_bf16 v[120:123], v[88:91], v[64:67], v[120:123]
    s_waitcnt lgkmcnt(1)
    v_mfma_f32_16x16x32_bf16 v[116:119], v[92:95], v[68:71], v[116:119]
    v_mfma_f32_16x16x32_bf16 v[120:123], v[96:99], v[68:71], v[120:123]
    s_waitcnt lgkmcnt(0)
    v_mfma_f32_16x16x32_bf16 v[116:119], v[100:103], v[72:75], v[116:119]
    v_mfma_f32_16x16x32_bf16 v[120:123], v[104:107], v[72:75], v[120:123]
    s_nop 6
    v_cvt_pk_bf16_f32 v116, v116, v117
    v_cvt_pk_bf16_f32 v117, v118, v119
    v_cvt_pk_bf16_f32 v118, v120, v121
    v_cvt_pk_bf16_f32 v119, v122, v123
    buffer_store_dwordx4 v[116:119], v24, s[24:27], s63 offen sc1
    v_add3_u32 v124, v116, v117, v118
    v_add_u32 v124, v124, v119
    v_mov_b32 v125, v124
    s_nop 1
    v_permlane16_swap_b32 v124, v125
    v_add_u32 v124, v124, v125
    v_mov_b32 v125, v124
    s_nop 1
    v_permlane32_swap_b32 v124, v125
    v_add_u32 v124, v124, v125
    v_add_u32 v124, s71, v124
    buffer_store_dword v124, v25, s[24:27], s64 offen sc1
    s_lshr_b32 s63, s61, 2
    s_and_b32 s64, s61, 3
    s_lshl3_add_u32 s65, s62, s63
    s_add_u32 s65, s65, 96
    s_mul_i32 s63, s63, 3
    s_max_u32 s59, s64, 1
    s_sub_u32 s59, s59, 1
    s_add_u32 s63, s63, s59
    s_lshl2_add_u32 s59, s63, s62
    s_cmp_eq_u32 s64, 1
    s_cselect_b32 s59, s65, s59
    s_mul_i32 s63, s59, 43691
    s_lshr_b32 s63, s63, 18
    s_mul_i32 s64, s63, 6
    s_sub_u32 s55, s59, s64
    s_lshl_b32 s63, s63, 2
    s_add_u32 s63, s63, s3
    s_mul_i32 s52, s55, 884736
    s_lshl_b32 s64, s63, 7
    s_add_u32 s52, s52, s64
    s_mul_i32 s53, s63, 12288
    s_lshl_b32 s64, s55, 6
    s_add_u32 s53, s53, s64
    s_add_u32 s53, s53, 1114112
    s_cmp_ge_u32 s59, 108
    s_cselect_b32 s52, 0x70000000, s52
    s_cselect_b32 s53, 0x70000000, s53
    s_mul_i32 s54, s3, 12288
    s_add_u32 s54, s54, 8192
    s_mul_i32 s64, s3, 18304
    s_add_u32 s52, s52, s64
    s_lshl_b32 s54, s3, 10
    s_add_u32 s54, s54, 8192
    v_lshrrev_b32 v4, 5, v1
    v_mul_u32_u24 v56, 9216, v4
    s_lshl_b32 s64, s3, 2
    v_lshl_add_u32 v4, v4, 1, s64
    v_and_b32 v5, 31, v1
    v_xor_b32 v4, v4, v5
    v_lshl_add_u32 v56, v4, 4, v56
    s_mov_b32 s56, s52
    s_add_u32 s57, s53, 384
    s_add_u32 s58, s54, 49152
    v_and_b32 v4, 1, v16
    v_lshlrev_b32 v4, 2, v4
    v_or_b32 v4, s3, v4
    v_lshlrev_b32 v4, 1, v4
    v_xor_b32 v4, v4, v19
    v_lshlrev_b32 v4, 4, v4
    v_lshl_add_u32 v57, v16, 13, v4
    s_lshl_b32 s63, s62, 20
    s_lshl_b32 s64, s3, 18
    s_add_u32 s63, s63, s64
    s_lshl_b32 s64, s61, 8
    s_add_u32 s63, s63, s64
    s_lshl_b32 s64, s3, 13
    s_add_u32 m0, s64, 106496
    s_waitcnt vmcnt(31)
    buffer_load_dwordx4 v57, s[16:19], s63 offen nt lds
    s_add_u32 m0, m0, 1024
    s_add_u32 s63, s63, 32768
    s_waitcnt vmcnt(31)
    buffer_load_dwordx4 v57, s[16:19], s63 offen nt lds
    s_add_u32 m0, m0, 1024
    s_add_u32 s63, s63, 32768
    s_waitcnt vmcnt(31)
    buffer_load_dwordx4 v57, s[16:19], s63 offen nt lds
    s_add_u32 m0, m0, 1024
    s_add_u32 s63, s63, 32768
    s_waitcnt vmcnt(31)
    buffer_load_dwordx4 v57, s[16:19], s63 offen nt lds
    s_add_u32 m0, m0, 1024
    s_add_u32 s63, s63, 32768
    s_waitcnt vmcnt(31)
    buffer_load_dwordx4 v57, s[16:19], s63 offen nt lds
    s_add_u32 m0, m0, 1024
    s_add_u32 s63, s63, 32768
    s_waitcnt vmcnt(31)
    buffer_load_dwordx4 v57, s[16:19], s63 offen nt lds
    s_add_u32 m0, m0, 1024
    s_add_u32 s63, s63, 32768
    s_waitcnt vmcnt(31)
    buffer_load_dwordx4 v57, s[16:19], s63 offen nt lds
    s_add_u32 m0, m0, 1024
    s_add_u32 s63, s63, 32768
    s_waitcnt vmcnt(31)
    buffer_load_dwordx4 v57, s[16:19], s63 offen nt lds
    s_mov_b32 m0, s54
    s_waitcnt vmcnt(23)
    buffer_load_dwordx4 v56, s[20:23], s52 offen nt lds
    s_add_u32 m0, m0, 4096
    s_add_u32 s52, s52, 73728
    s_waitcnt vmcnt(23)
    buffer_load_dwordx4 v56, s[20:23], s52 offen nt lds
    s_add_u32 m0, m0, 4096
    s_add_u32 s52, s52, 73728
    s_waitcnt vmcnt(23)
    buffer_load_dwordx4 v56, s[20:23], s52 offen nt lds
    s_add_u32 m0, m0, 4096
    s_add_u32 s52, s52, 73728
    s_waitcnt vmcnt(23)
    buffer_load_dwordx4 v56, s[20:23], s52 offen nt lds
    s_add_u32 m0, m0, 4096
    s_add_u32 s52, s52, 73728
    s_waitcnt vmcnt(23)
    buffer_load_dwordx4 v56, s[20:23], s52 offen nt lds
    s_add_u32 m0, m0, 4096
    s_add_u32 s52, s52, 73728
    s_waitcnt vmcnt(23)
    buffer_load_dwordx4 v56, s[20:23], s52 offen nt lds
    s_add_u32 m0, m0, 4096
    s_add_u32 s52, s52, 73728
    s_waitcnt vmcnt(23)
    buffer_load_dwordx4 v56, s[20:23], s52 offen nt lds
    s_add_u32 m0, m0, 4096
    s_add_u32 s52, s52, 73728
    s_waitcnt vmcnt(23)
    buffer_load_dwordx4 v56, s[20:23], s52 offen nt lds
    s_add_u32 m0, m0, 4096
    s_add_u32 s52, s52, 73728
    s_waitcnt vmcnt(23)
    buffer_load_dwordx4 v56, s[20:23], s52 offen nt lds
    s_add_u32 m0, m0, 4096
    s_add_u32 s52, s52, 73728
    s_waitcnt vmcnt(23)
    buffer_load_dwordx4 v56, s[20:23], s52 offen nt lds
    s_add_u32 m0, m0, 4096
    s_add_u32 s52, s52, 73728
    s_waitcnt vmcnt(23)
    buffer_load_dwordx4 v56, s[20:23], s52 offen nt lds
    s_add_u32 m0, m0, 4096
    s_add_u32 s52, s52, 73728
    s_waitcnt vmcnt(23)
    buffer_load_dwordx4 v56, s[20:23], s52 offen nt lds
    s_mul_i32 s63, s55, 192
    s_add_u32 s63, s63, 0
    v_mul_u32_u24 v4, 1152, v18
    v_lshl_add_u32 v4, v16, 3, v4
    v_add_u32 v4, s63, v4
    ds_read2_b64 v[60:63], v4 offset0:0 offset1:4
    ds_read2_b64 v[64:67], v4 offset0:8 offset1:12
    ds_read2_b64 v[68:71], v4 offset0:16 offset1:20
    s_lshl_b32 s63, s3, 2
    v_lshrrev_b32 v5, 1, v18
    v_add_u32 v5, s63, v5
    v_xor_b32 v4, v26, v5
    v_lshl_add_u32 v4, v4, 4, v27
    v_lshlrev_b32 v5, 13, v17
    v_lshl_add_u32 v5, v16, 8, v5
    v_add3_u32 v72, v4, v5, s67
    v_add_u32 v72, 102401, v72
    v_xor_b32 v73, 32, v72
    v_cmp_gt_u32 vcc, 8, v19
    s_nop 1
    v_cndmask_b32 v92, 0, -1, vcc
    v_and_b32 v4, 1, v1
    v_lshlrev_b32 v4, 4, v4
    v_mov_b32 v5, 0xffff
    v_lshlrev_b32 v5, v4, v5
    v_lshrrev_b32 v4, 1, v19
    v_cmp_eq_u32 vcc, 0, v4
    s_nop 1
    v_cndmask_b32 v76, 0, v5, vcc
    v_cmp_eq_u32 vcc, 1, v4
    s_nop 1
    v_cndmask_b32 v77, 0, v5, vcc
    v_cmp_eq_u32 vcc, 2, v4
    s_nop 1
    v_cndmask_b32 v78, 0, v5, vcc
    v_cmp_eq_u32 vcc, 3, v4
    s_nop 1
    v_cndmask_b32 v79, 0, v5, vcc
    v_and_b32 v4, 7, v1
    v_lshl_add_u32 v4, v16, 3, v4
    v_mul_u32_u24 v80, 2176, v4
    v_mul_u32_u24 v84, 264192, v16
    v_lshl_add_u32 v84, v19, 4, v84
    v_add_u32 v85, 33024, v84
    v_add_u32 v86, 66048, v84
    v_add_u32 v87, 99072, v84
    v_add_u32 v88, 132096, v84
    v_add_u32 v89, 165120, v84
    v_add_u32 v90, 198144, v84
    v_add_u32 v91, 231168, v84
    s_lshl_b32 s63, s3, 4
    v_lshlrev_b32 v93, 6, v19
    v_lshl_add_u32 v93, v16, 3, v93
    v_add_u32 v93, s63, v93
    s_mov_b32 m0, s58
    s_waitcnt vmcnt(23)
    buffer_load_dwordx4 v56, s[28:31], s56 offen nt lds
    s_add_u32 m0, m0, 4096
    s_add_u32 s56, s56, 73728
    s_waitcnt vmcnt(23)
    buffer_load_dwordx4 v56, s[28:31], s56 offen nt lds
    s_add_u32 m0, m0, 4096
    s_add_u32 s56, s56, 73728
    s_waitcnt vmcnt(23)
    buffer_load_dwordx4 v56, s[28:31], s56 offen nt lds
    s_add_u32 m0, m0, 4096
    s_add_u32 s56, s56, 73728
    s_waitcnt vmcnt(23)
    buffer_load_dwordx4 v56, s[28:31], s56 offen nt lds
    s_add_u32 m0, m0, 4096
    s_add_u32 s56, s56, 73728
    s_waitcnt vmcnt(23)
    buffer_load_dwordx4 v56, s[28:31], s56 offen nt lds
    s_add_u32 m0, m0, 4096
    s_add_u32 s56, s56, 73728
    s_waitcnt vmcnt(23)
    buffer_load_dwordx4 v56, s[28:31], s56 offen nt lds
    s_add_u32 m0, m0, 4096
    s_add_u32 s56, s56, 73728
    s_waitcnt vmcnt(23)
    buffer_load_dwordx4 v56, s[28:31], s56 offen nt lds
    s_add_u32 m0, m0, 4096
    s_add_u32 s56, s56, 73728
    s_waitcnt vmcnt(23)
    buffer_load_dwordx4 v56, s[28:31], s56 offen nt lds
    s_add_u32 m0, m0, 4096
    s_add_u32 s56, s56, 73728
    s_waitcnt vmcnt(23)
    buffer_load_dwordx4 v56, s[28:31], s56 offen nt lds
    s_add_u32 m0, m0, 4096
    s_add_u32 s56, s56, 73728
    s_waitcnt vmcnt(23)
    buffer_load_dwordx4 v56, s[28:31], s56 offen nt lds
    s_add_u32 m0, m0, 4096
    s_add_u32 s56, s56, 73728
    s_waitcnt vmcnt(23)
    buffer_load_dwordx4 v56, s[28:31], s56 offen nt lds
    s_add_u32 m0, m0, 4096
    s_add_u32 s56, s56, 73728
    s_waitcnt vmcnt(23)
    buffer_load_dwordx4 v56, s[28:31], s56 offen nt lds
    v_lshl_add_u32 v7, v16, 2, v17
    v_and_b32 v4, 6, v7
    v_lshrrev_b32 v5, 1, v18
    v_xor_b32 v4, v4, v5
    v_and_b32 v6, 1, v18
    v_lshlrev_b32 v6, 3, v6
    v_lshl_add_u32 v4, v4, 4, v6
    v_lshl_add_u32 v4, v7, 7, v4
    v_and_b32 v4, 7, v7
    v_lshlrev_b32 v4, 1, v4
    s_lshl_b32 s63, s3, 3
    v_add_u32 v5, s63, v5
    v_xor_b32 v4, v4, v5
    v_lshl_add_u32 v4, v4, 4, v6
    v_lshl_add_u32 v4, v7, 9, v4
    v_add_u32 v164, 8192, v4
    v_xor_b32 v165, 32, v164
    v_xor_b32 v166, 64, v164
    v_xor_b32 v167, 96, v164
    v_mul_u32_u24 v168, 768, v16
    v_lshl_add_u32 v168, v18, 4, v168
    v_lshl_add_u32 v168, v17, 28, v168
    s_waitcnt vmcnt(12)
    s_barrier
    ds_read_b64_tr_b16 v[100:101], v164 offset:0
    ds_read_b64_tr_b16 v[102:103], v164 offset:8192
    ds_read_b64_tr_b16 v[104:105], v165 offset:0
    ds_read_b64_tr_b16 v[106:107], v165 offset:8192
    ds_read_b64_tr_b16 v[108:109], v166 offset:0
    ds_read_b64_tr_b16 v[110:111], v166 offset:8192
    ds_read_b64_tr_b16 v[112:113], v167 offset:0
    ds_read_b64_tr_b16 v[114:115], v167 offset:8192
    ds_read_b64_tr_b16 v[116:117], v164 offset:16384
    ds_read_b64_tr_b16 v[118:119], v164 offset:24576
    ds_read_b64_tr_b16 v[120:121], v165 offset:16384
    ds_read_b64_tr_b16 v[122:123], v165 offset:24576
    ds_read_b64_tr_b16 v[124:125], v166 offset:16384
    ds_read_b64_tr_b16 v[126:127], v166 offset:24576
    ds_read_b64_tr_b16 v[128:129], v167 offset:16384
    ds_read_b64_tr_b16 v[130:131], v167 offset:24576
    s_waitcnt lgkmcnt(8)
    v_mfma_f32_16x16x32_bf16 v[148:151], v[100:103], v[60:63], 0
    v_mfma_f32_16x16x32_bf16 v[152:155], v[104:107], v[60:63], 0
    v_mfma_f32_16x16x32_bf16 v[156:159], v[108:111], v[60:63], 0
    v_mfma_f32_16x16x32_bf16 v[160:163], v[112:115], v[60:63], 0
    ds_read_b64_tr_b16 v[132:133], v164 offset:32768
    ds_read_b64_tr_b16 v[134:135], v164 offset:40960
    ds_read_b64_tr_b16 v[136:137], v165 offset:32768
    ds_read_b64_tr_b16 v[138:139], v165 offset:40960
    ds_read_b64_tr_b16 v[140:141], v166 offset:32768
    ds_read_b64_tr_b16 v[142:143], v166 offset:40960
    ds_read_b64_tr_b16 v[144:145], v167 offset:32768
    ds_read_b64_tr_b16 v[146:147], v167 offset:40960
    s_waitcnt lgkmcnt(8)
    v_mfma_f32_16x16x32_bf16 v[148:151], v[116:119], v[64:67], v[148:151]
    v_mfma_f32_16x16x32_bf16 v[152:155], v[120:123], v[64:67], v[152:155]
    v_mfma_f32_16x16x32_bf16 v[156:159], v[124:127], v[64:67], v[156:159]
    v_mfma_f32_16x16x32_bf16 v[160:163], v[128:131], v[64:67], v[160:163]
    s_waitcnt lgkmcnt(6)
    v_mfma_f32_16x16x32_bf16 v[148:151], v[132:135], v[68:71], v[148:151]
    s_waitcnt lgkmcnt(4)
    v_mfma_f32_16x16x32_bf16 v[152:155], v[136:139], v[68:71], v[152:155]
    s_waitcnt lgkmcnt(2)
    v_mfma_f32_16x16x32_bf16 v[156:159], v[140:143], v[68:71], v[156:159]
    s_waitcnt lgkmcnt(0)
    v_mfma_f32_16x16x32_bf16 v[160:163], v[144:147], v[68:71], v[160:163]
    s_nop 1
    v_and_or_b32 v148, v148, s68, v3
    v_and_or_b32 v149, v149, s68, v3
    v_and_or_b32 v150, v150, s68, v3
    v_and_or_b32 v151, v151, s68, v3
    buffer_store_dwordx4 v[148:151], v168, s[24:27], s53 offen offset:0 sc1
    v_and_or_b32 v152, v152, s68, v3
    v_and_or_b32 v153, v153, s68, v3
    v_and_or_b32 v154, v154, s68, v3
    v_and_or_b32 v155, v155, s68, v3
    buffer_store_dwordx4 v[152:155], v168, s[24:27], s53 offen offset:3072 sc1
    s_add_u32 s53, s53, 6144
    v_and_or_b32 v156, v156, s68, v3
    v_and_or_b32 v157, v157, s68, v3
    v_and_or_b32 v158, v158, s68, v3
    v_and_or_b32 v159, v159, s68, v3
    buffer_store_dwordx4 v[156:159], v168, s[24:27], s53 offen offset:0 sc1
    v_and_or_b32 v160, v160, s68, v3
    v_and_or_b32 v161, v161, s68, v3
    v_and_or_b32 v162, v162, s68, v3
    v_and_or_b32 v163, v163, s68, v3
    buffer_store_dwordx4 v[160:163], v168, s[24:27], s53 offen offset:3072 sc1
    s_mul_i32 s59, s3, 69632
    s_lshl_b32 s64, s62, 9
    s_add_u32 s59, s59, s64
    s_lshl_b32 s64, s61, 4
    s_add_u32 s59, s59, s64
    s_add_u32 s59, s59, 524288
    v_lshl_add_u32 v7, v16, 2, v17
    v_and_b32 v4, 6, v7
    v_lshrrev_b32 v5, 1, v18
    v_xor_b32 v4, v4, v5
    v_and_b32 v6, 1, v18
    v_lshlrev_b32 v6, 3, v6
    v_lshl_add_u32 v4, v4, 4, v6
    v_lshl_add_u32 v4, v7, 7, v4
    v_and_b32 v4, 7, v7
    v_lshlrev_b32 v4, 1, v4
    s_lshl_b32 s63, s3, 3
    v_add_u32 v5, s63, v5
    v_xor_b32 v4, v4, v5
    v_lshl_add_u32 v4, v4, 4, v6
    v_lshl_add_u32 v4, v7, 9, v4
    v_add_u32 v164, 57344, v4
    v_xor_b32 v165, 32, v164
    v_xor_b32 v166, 64, v164
    v_xor_b32 v167, 96, v164
    v_mul_u32_u24 v168, 768, v16
    v_lshl_add_u32 v168, v18, 4, v168
    v_lshl_add_u32 v168, v17, 28, v168
    s_waitcnt vmcnt(4)
    s_barrier
    buffer_load_dwordx4 v[96:99], v80, s[24:27], s59 offen sc1
    ds_read_b64_tr_b16 a[0:1], v72 offset:0
    ds_read_b64_tr_b16 a[2:3], v72 offset:4096
    ds_read_b64_tr_b16 a[4:5], v73 offset:0
    ds_read_b64_tr_b16 a[6:7], v73 offset:4096
    ds_read_b64_tr_b16 a[8:9], v72 offset:1024
    ds_read_b64_tr_b16 a[10:11], v72 offset:5120
    ds_read_b64_tr_b16 a[12:13], v73 offset:1024
    ds_read_b64_tr_b16 a[14:15], v73 offset:5120
    ds_read_b64_tr_b16 a[16:17], v72 offset:2048
    ds_read_b64_tr_b16 a[18:19], v72 offset:6144
    ds_read_b64_tr_b16 a[20:21], v73 offset:2048
    ds_read_b64_tr_b16 a[22:23], v73 offset:6144
    ds_read_b64_tr_b16 a[24:25], v72 offset:3072
    ds_read_b64_tr_b16 a[26:27], v72 offset:7168
    ds_read_b64_tr_b16 a[28:29], v73 offset:3072
    ds_read_b64_tr_b16 a[30:31], v73 offset:7168
    s_waitcnt lgkmcnt(0)
    ds_read_b64_tr_b16 v[100:101], v164 offset:0
    ds_read_b64_tr_b16 v[102:103], v164 offset:8192
    ds_read_b64_tr_b16 v[104:105], v165 offset:0
    ds_read_b64_tr_b16 v[106:107], v165 offset:8192
    ds_read_b64_tr_b16 v[108:109], v166 offset:0
    ds_read_b64_tr_b16 v[110:111], v166 offset:8192
    ds_read_b64_tr_b16 v[112:113], v167 offset:0
    ds_read_b64_tr_b16 v[114:115], v167 offset:8192
    ds_read_b64_tr_b16 v[116:117], v164 offset:16384
    ds_read_b64_tr_b16 v[118:119], v164 offset:24576
    ds_read_b64_tr_b16 v[120:121], v165 offset:16384
    ds_read_b64_tr_b16 v[122:123], v165 offset:24576
    ds_read_b64_tr_b16 v[124:125], v166 offset:16384
    ds_read_b64_tr_b16 v[126:127], v166 offset:24576
    ds_read_b64_tr_b16 v[128:129], v167 offset:16384
    ds_read_b64_tr_b16 v[130:131], v167 offset:24576
    s_waitcnt lgkmcnt(8)
    v_mfma_f32_16x16x32_bf16 v[148:151], v[100:103], v[60:63], 0
    v_mfma_f32_16x16x32_bf16 v[152:155], v[104:107], v[60:63], 0
    v_mfma_f32_16x16x32_bf16 v[156:159], v[108:111], v[60:63], 0
    v_mfma_f32_16x16x32_bf16 v[160:163], v[112:115], v[60:63], 0
    ds_read_b64_tr_b16 v[132:133], v164 offset:32768
    ds_read_b64_tr_b16 v[134:135], v164 offset:40960
    ds_read_b64_tr_b16 v[136:137], v165 offset:32768
    ds_read_b64_tr_b16 v[138:139], v165 offset:40960
    ds_read_b64_tr_b16 v[140:141], v166 offset:32768
    ds_read_b64_tr_b16 v[142:143], v166 offset:40960
    ds_read_b64_tr_b16 v[144:145], v167 offset:32768
    ds_read_b64_tr_b16 v[146:147], v167 offset:40960
    s_waitcnt lgkmcnt(8)
    v_mfma_f32_16x16x32_bf16 v[148:151], v[116:119], v[64:67], v[148:151]
    v_mfma_f32_16x16x32_bf16 v[152:155], v[120:123], v[64:67], v[152:155]
    v_mfma_f32_16x16x32_bf16 v[156:159], v[124:127], v[64:67], v[156:159]
    v_mfma_f32_16x16x32_bf16 v[160:163], v[128:131], v[64:67], v[160:163]
    s_waitcnt lgkmcnt(6)
    v_mfma_f32_16x16x32_bf16 v[148:151], v[132:135], v[68:71], v[148:151]
    s_waitcnt lgkmcnt(4)
    v_mfma_f32_16x16x32_bf16 v[152:155], v[136:139], v[68:71], v[152:155]
    s_waitcnt lgkmcnt(2)
    v_mfma_f32_16x16x32_bf16 v[156:159], v[140:143], v[68:71], v[156:159]
    s_waitcnt lgkmcnt(0)
    v_mfma_f32_16x16x32_bf16 v[160:163], v[144:147], v[68:71], v[160:163]
    s_nop 1
    v_and_or_b32 v148, v148, s68, v3
    v_and_or_b32 v149, v149, s68, v3
    v_and_or_b32 v150, v150, s68, v3
    v_and_or_b32 v151, v151, s68, v3
    buffer_store_dwordx4 v[148:151], v168, s[24:27], s57 offen offset:0 sc1
    v_and_or_b32 v152, v152, s68, v3
    v_and_or_b32 v153, v153, s68, v3
    v_and_or_b32 v154, v154, s68, v3
    v_and_or_b32 v155, v155, s68, v3
    buffer_store_dwordx4 v[152:155], v168, s[24:27], s57 offen offset:3072 sc1
    s_add_u32 s57, s57, 6144
    v_and_or_b32 v156, v156, s68, v3
    v_and_or_b32 v157, v157, s68, v3
    v_and_or_b32 v158, v158, s68, v3
    v_and_or_b32 v159, v159, s68, v3
    buffer_store_dwordx4 v[156:159], v168, s[24:27], s57 offen offset:0 sc1
    v_and_or_b32 v160, v160, s68, v3
    v_and_or_b32 v161, v161, s68, v3
    v_and_or_b32 v162, v162, s68, v3
    v_and_or_b32 v163, v163, s68, v3
    buffer_store_dwordx4 v[160:163], v168, s[24:27], s57 offen offset:3072 sc1
    s_lshl_b32 s65, s3, 9
    s_mul_i32 s63, s70, 2176
    s_add_u32 s63, s63, s65
    s_add_u32 s63, s63, 524288
    s_mul_i32 s63, s3, 69632
    s_lshl_b32 s64, s62, 9
    s_add_u32 s63, s63, s64
    s_lshl_b32 s64, s61, 4
    s_add_u32 s63, s63, s64
    s_add_u32 s63, s63, 524288
    s_lshl_b32 s64, s70, 11
    s_add_u32 s65, s65, s64
    s_add_u32 s65, s65, 802816
    s_mul_i32 s64, s70, 33024
    s_lshl_b32 s66, s3, 13
    s_add_u32 s64, s64, s66
    s_add_u32 s64, s64, 3342336
    s_and_b32 s64, s61, 0x19
    s_and_b32 s66, s61, 2
    s_lshl1_add_u32 s64, s66, s64
    s_bfe_u32 s66, s61, 0x10002
    s_lshl1_add_u32 s64, s66, s64
    s_lshl_b32 s64, s64, 8
    s_lshl_b32 s66, s62, 13
    s_add_u32 s64, s64, s66
    s_mul_i32 s66, s3, 1056768
    s_add_u32 s64, s64, s66
    s_add_u32 s64, s64, 3342336
    s_mov_b64 s[50:51], 0
    s_mov_b64 s[52:53], 0
    s_mov_b32 s56, 0x00010001
    s_mov_b32 s57, 0x00010001
    s_mov_b32 s69, 40000
    s_lshl1_add_u32 s66, s71, 1
    s_waitcnt vmcnt(4)
    s_branch L_g1
L_g0:
    s_waitcnt vmcnt(0)
L_g1:
    v_add3_u32 v164, v96, v97, v98
    v_add_u32 v164, s66, v164
    v_cmp_eq_u32 vcc, v164, v99
    s_sub_u32 s69, s69, 1
    s_nop 2
    s_cbranch_scc1 L_g2
    s_andn2_b64 s[54:55], vcc, s[52:53]
    s_or_b64 s[52:53], s[52:53], vcc
    s_not_b64 exec, s[52:53]
    s_andn2_b64 s[54:55], s[54:55], s[50:51]
    s_bcnt1_i32_b64 s48, exec
    s_cmp_le_u32 s48, 16
    s_cselect_b64 s[50:51], exec, 0
    s_or_b64 s[54:55], s[54:55], s[50:51]
    s_or_b64 s[48:49], s[54:55], exec
    s_cbranch_scc0 L_g4
    buffer_load_dwordx4 v[96:99], v80, s[24:27], s59 offen sc1
    s_mov_b64 exec, -1
    s_cmp_eq_u64 s[54:55], 0
    s_cbranch_scc1 L_g0
    s_and_b64 s[46:47], s[54:55], s[56:57]
    s_mul_i32 exec_lo, s46, 0xffff
    s_mul_i32 exec_hi, s47, 0xffff
    buffer_load_dwordx4 v[100:103], v84, s[24:27], s64 offen sc1
    s_lshr_b64 s[54:55], s[54:55], 1
    s_and_b64 s[46:47], s[54:55], s[56:57]
    s_mul_i32 exec_lo, s46, 0xffff
    s_mul_i32 exec_hi, s47, 0xffff
    buffer_load_dwordx4 v[104:107], v85, s[24:27], s64 offen sc1
    s_lshr_b64 s[54:55], s[54:55], 1
    s_and_b64 s[46:47], s[54:55], s[56:57]
    s_mul_i32 exec_lo, s46, 0xffff
    s_mul_i32 exec_hi, s47, 0xffff
    buffer_load_dwordx4 v[108:111], v86, s[24:27], s64 offen sc1
    s_lshr_b64 s[54:55], s[54:55], 1
    s_and_b64 s[46:47], s[54:55], s[56:57]
    s_mul_i32 exec_lo, s46, 0xffff
    s_mul_i32 exec_hi, s47, 0xffff
    buffer_load_dwordx4 v[112:115], v87, s[24:27], s64 offen sc1
    s_lshr_b64 s[54:55], s[54:55], 1
    s_and_b64 s[46:47], s[54:55], s[56:57]
    s_mul_i32 exec_lo, s46, 0xffff
    s_mul_i32 exec_hi, s47, 0xffff
    buffer_load_dwordx4 v[116:119], v88, s[24:27], s64 offen sc1
    s_lshr_b64 s[54:55], s[54:55], 1
    s_and_b64 s[46:47], s[54:55], s[56:57]
    s_mul_i32 exec_lo, s46, 0xffff
    s_mul_i32 exec_hi, s47, 0xffff
    buffer_load_dwordx4 v[120:123], v89, s[24:27], s64 offen sc1
    s_lshr_b64 s[54:55], s[54:55], 1
    s_and_b64 s[46:47], s[54:55], s[56:57]
    s_mul_i32 exec_lo, s46, 0xffff
    s_mul_i32 exec_hi, s47, 0xffff
    buffer_load_dwordx4 v[124:127], v90, s[24:27], s64 offen sc1
    s_lshr_b64 s[54:55], s[54:55], 1
    s_and_b64 s[46:47], s[54:55], s[56:57]
    s_mul_i32 exec_lo, s46, 0xffff
    s_mul_i32 exec_hi, s47, 0xffff
    buffer_load_dwordx4 v[128:131], v91, s[24:27], s64 offen sc1
    s_mov_b64 exec, -1
    s_cmp_eq_u64 s[52:53], -1
    s_cbranch_scc1 L_g2
    s_waitcnt vmcnt(8)
    s_branch L_g1
L_g4:
    s_mov_b64 exec, -1
L_g2:
    s_mov_b32 s69, 40000
    v_mov_b32 v166, v96
    s_nop 1
    v_max_f32_dpp v166, v166, v166 quad_perm:[1,0,3,2] row_mask:0xf bank_mask:0xf
    s_nop 1
    v_max_f32_dpp v166, v166, v166 quad_perm:[2,3,0,1] row_mask:0xf bank_mask:0xf
    s_nop 1
    v_max_f32_dpp v166, v166, v166 row_half_mirror row_mask:0xf bank_mask:0xf
    v_mov_b32 v164, v166
    s_nop 1
    v_permlane16_swap_b32 v166, v164
    v_max_f32 v166, v166, v164
    v_mov_b32 v164, v166
    s_nop 1
    v_permlane32_swap_b32 v166, v164
    v_max_f32 v166, v166, v164
    v_sub_f32 v168, v96, v166
    v_exp_f32 v168, v168
    s_nop 0
    v_cvt_pk_bf16_f32 v168, v168, v168
    v_and_b32 v167, 0xffff0000, v168
    v_mul_f32 v167, v167, v97
    v_and_b32_dpp v132, v168, v76 row_newbcast:0 row_mask:0xf bank_mask:0xf
    v_and_b32_dpp v133, v168, v77 row_newbcast:0 row_mask:0xf bank_mask:0xf
    v_and_b32_dpp v134, v168, v78 row_newbcast:0 row_mask:0xf bank_mask:0xf
    v_and_b32_dpp v135, v168, v79 row_newbcast:0 row_mask:0xf bank_mask:0xf
    v_and_b32_dpp v136, v168, v76 row_newbcast:1 row_mask:0xf bank_mask:0xf
    v_and_b32_dpp v137, v168, v77 row_newbcast:1 row_mask:0xf bank_mask:0xf
    v_and_b32_dpp v138, v168, v78 row_newbcast:1 row_mask:0xf bank_mask:0xf
    v_and_b32_dpp v139, v168, v79 row_newbcast:1 row_mask:0xf bank_mask:0xf
    v_and_b32_dpp v140, v168, v76 row_newbcast:2 row_mask:0xf bank_mask:0xf
    v_and_b32_dpp v141, v168, v77 row_newbcast:2 row_mask:0xf bank_mask:0xf
    v_and_b32_dpp v142, v168, v78 row_newbcast:2 row_mask:0xf bank_mask:0xf
    v_and_b32_dpp v143, v168, v79 row_newbcast:2 row_mask:0xf bank_mask:0xf
    v_and_b32_dpp v144, v168, v76 row_newbcast:3 row_mask:0xf bank_mask:0xf
    v_and_b32_dpp v145, v168, v77 row_newbcast:3 row_mask:0xf bank_mask:0xf
    v_and_b32_dpp v146, v168, v78 row_newbcast:3 row_mask:0xf bank_mask:0xf
    v_and_b32_dpp v147, v168, v79 row_newbcast:3 row_mask:0xf bank_mask:0xf
    v_and_b32_dpp v148, v168, v76 row_newbcast:4 row_mask:0xf bank_mask:0xf
    v_and_b32_dpp v149, v168, v77 row_newbcast:4 row_mask:0xf bank_mask:0xf
    v_and_b32_dpp v150, v168, v78 row_newbcast:4 row_mask:0xf bank_mask:0xf
    v_and_b32_dpp v151, v168, v79 row_newbcast:4 row_mask:0xf bank_mask:0xf
    v_and_b32_dpp v152, v168, v76 row_newbcast:5 row_mask:0xf bank_mask:0xf
    v_and_b32_dpp v153, v168, v77 row_newbcast:5 row_mask:0xf bank_mask:0xf
    v_and_b32_dpp v154, v168, v78 row_newbcast:5 row_mask:0xf bank_mask:0xf
    v_and_b32_dpp v155, v168, v79 row_newbcast:5 row_mask:0xf bank_mask:0xf
    v_and_b32_dpp v156, v168, v76 row_newbcast:6 row_mask:0xf bank_mask:0xf
    v_and_b32_dpp v157, v168, v77 row_newbcast:6 row_mask:0xf bank_mask:0xf
    v_and_b32_dpp v158, v168, v78 row_newbcast:6 row_mask:0xf bank_mask:0xf
    v_and_b32_dpp v159, v168, v79 row_newbcast:6 row_mask:0xf bank_mask:0xf
    v_and_b32_dpp v160, v168, v76 row_newbcast:7 row_mask:0xf bank_mask:0xf
    v_and_b32_dpp v161, v168, v77 row_newbcast:7 row_mask:0xf bank_mask:0xf
    v_and_b32_dpp v162, v168, v78 row_newbcast:7 row_mask:0xf bank_mask:0xf
    v_and_b32_dpp v163, v168, v79 row_newbcast:7 row_mask:0xf bank_mask:0xf
    v_add_f32_dpp v167, v167, v167 quad_perm:[1,0,3,2] row_mask:0xf bank_mask:0xf
    s_nop 1
    v_add_f32_dpp v167, v167, v167 quad_perm:[2,3,0,1] row_mask:0xf bank_mask:0xf
    s_nop 1
    v_add_f32_dpp v167, v167, v167 row_half_mirror row_mask:0xf bank_mask:0xf
    v_mov_b32 v164, v167
    s_nop 1
    v_permlane16_swap_b32 v167, v164
    v_add_f32 v167, v167, v164
    v_mov_b32 v164, v167
    s_nop 1
    v_permlane32_swap_b32 v167, v164
    v_add_f32 v167, v167, v164
    v_rcp_f32 v167, v167
    s_nop 0
    s_branch Lpc_5
Lp_3:
    v_add3_u32 v176, v100, v101, v102
    v_add_u32 v176, v103, v176
    v_add3_u32 v177, v104, v105, v106
    v_add_u32 v177, v107, v177
    v_add3_u32 v178, v108, v109, v110
    v_add_u32 v178, v111, v178
    v_add3_u32 v179, v112, v113, v114
    v_add_u32 v179, v115, v179
    v_add3_u32 v180, v116, v117, v118
    v_add_u32 v180, v119, v180
    v_add3_u32 v181, v120, v121, v122
    v_add_u32 v181, v123, v181
    v_add3_u32 v182, v124, v125, v126
    v_add_u32 v182, v127, v182
    v_add3_u32 v183, v128, v129, v130
    v_add_u32 v183, v131, v183
    v_add_u32_dpp v176, v176, v176 quad_perm:[1,0,3,2] row_mask:0xf bank_mask:0xf
    v_add_u32_dpp v177, v177, v177 quad_perm:[1,0,3,2] row_mask:0xf bank_mask:0xf
    v_add_u32_dpp v178, v178, v178 quad_perm:[1,0,3,2] row_mask:0xf bank_mask:0xf
    v_add_u32_dpp v179, v179, v179 quad_perm:[1,0,3,2] row_mask:0xf bank_mask:0xf
    v_add_u32_dpp v180, v180, v180 quad_perm:[1,0,3,2] row_mask:0xf bank_mask:0xf
    v_add_u32_dpp v181, v181, v181 quad_perm:[1,0,3,2] row_mask:0xf bank_mask:0xf
    v_add_u32_dpp v182, v182, v182 quad_perm:[1,0,3,2] row_mask:0xf bank_mask:0xf
    v_add_u32_dpp v183, v183, v183 quad_perm:[1,0,3,2] row_mask:0xf bank_mask:0xf
    v_add_u32_dpp v176, v176, v176 quad_perm:[2,3,0,1] row_mask:0xf bank_mask:0xf
    v_add_u32_dpp v177, v177, v177 quad_perm:[2,3,0,1] row_mask:0xf bank_mask:0xf
    v_add_u32_dpp v178, v178, v178 quad_perm:[2,3,0,1] row_mask:0xf bank_mask:0xf
    v_add_u32_dpp v179, v179, v179 quad_perm:[2,3,0,1] row_mask:0xf bank_mask:0xf
    v_add_u32_dpp v180, v180, v180 quad_perm:[2,3,0,1] row_mask:0xf bank_mask:0xf
    v_add_u32_dpp v181, v181, v181 quad_perm:[2,3,0,1] row_mask:0xf bank_mask:0xf
    v_add_u32_dpp v182, v182, v182 quad_perm:[2,3,0,1] row_mask:0xf bank_mask:0xf
    v_add_u32_dpp v183, v183, v183 quad_perm:[2,3,0,1] row_mask:0xf bank_mask:0xf
    v_add_u32_dpp v176, v176, v176 row_half_mirror row_mask:0xf bank_mask:0xf
    v_add_u32_dpp v177, v177, v177 row_half_mirror row_mask:0xf bank_mask:0xf
    v_add_u32_dpp v178, v178, v178 row_half_mirror row_mask:0xf bank_mask:0xf
    v_add_u32_dpp v179, v179, v179 row_half_mirror row_mask:0xf bank_mask:0xf
    v_add_u32_dpp v180, v180, v180 row_half_mirror row_mask:0xf bank_mask:0xf
    v_add_u32_dpp v181, v181, v181 row_half_mirror row_mask:0xf bank_mask:0xf
    v_add_u32_dpp v182, v182, v182 row_half_mirror row_mask:0xf bank_mask:0xf
    v_add_u32_dpp v183, v183, v183 row_half_mirror row_mask:0xf bank_mask:0xf
    v_add_u32_dpp v176, v176, v176 row_mirror row_mask:0xf bank_mask:0xf
    v_add_u32_dpp v177, v177, v177 row_mirror row_mask:0xf bank_mask:0xf
    v_add_u32_dpp v178, v178, v178 row_mirror row_mask:0xf bank_mask:0xf
    v_add_u32_dpp v179, v179, v179 row_mirror row_mask:0xf bank_mask:0xf
    v_add_u32_dpp v180, v180, v180 row_mirror row_mask:0xf bank_mask:0xf
    v_add_u32_dpp v181, v181, v181 row_mirror row_mask:0xf bank_mask:0xf
    v_add_u32_dpp v182, v182, v182 row_mirror row_mask:0xf bank_mask:0xf
    v_add_u32_dpp v183, v183, v183 row_mirror row_mask:0xf bank_mask:0xf
    v_sub_u32_dpp v176, v98, v176 row_newbcast:0 row_mask:0xf bank_mask:0xf
    v_sub_u32_dpp v177, v98, v177 row_newbcast:1 row_mask:0xf bank_mask:0xf
    v_sub_u32_dpp v178, v98, v178 row_newbcast:2 row_mask:0xf bank_mask:0xf
    v_sub_u32_dpp v179, v98, v179 row_newbcast:3 row_mask:0xf bank_mask:0xf
    v_sub_u32_dpp v180, v98, v180 row_newbcast:4 row_mask:0xf bank_mask:0xf
    v_sub_u32_dpp v181, v98, v181 row_newbcast:5 row_mask:0xf bank_mask:0xf
    v_sub_u32_dpp v182, v98, v182 row_newbcast:6 row_mask:0xf bank_mask:0xf
    v_sub_u32_dpp v183, v98, v183 row_newbcast:7 row_mask:0xf bank_mask:0xf
    v_cmp_ne_u32 s[36:37], s71, v176
    v_cmp_ne_u32 s[38:39], s71, v177
    v_cmp_ne_u32 s[40:41], s71, v178
    v_cmp_ne_u32 s[42:43], s71, v179
    v_cmp_ne_u32 s[44:45], s71, v180
    v_cmp_ne_u32 s[46:47], s71, v181
    v_cmp_ne_u32 s[48:49], s71, v182
    v_cmp_ne_u32 s[50:51], s71, v183
    s_mov_b64 exec, s[36:37]
    buffer_load_dwordx4 v[100:103], v84, s[24:27], s64 offen sc1
    s_mov_b64 exec, s[38:39]
    buffer_load_dwordx4 v[104:107], v85, s[24:27], s64 offen sc1
    s_mov_b64 exec, s[40:41]
    buffer_load_dwordx4 v[108:111], v86, s[24:27], s64 offen sc1
    s_mov_b64 exec, s[42:43]
    buffer_load_dwordx4 v[112:115], v87, s[24:27], s64 offen sc1
    s_mov_b64 exec, s[44:45]
    buffer_load_dwordx4 v[116:119], v88, s[24:27], s64 offen sc1
    s_mov_b64 exec, s[46:47]
    buffer_load_dwordx4 v[120:123], v89, s[24:27], s64 offen sc1
    s_mov_b64 exec, s[48:49]
    buffer_load_dwordx4 v[124:127], v90, s[24:27], s64 offen sc1
    s_mov_b64 exec, s[50:51]
    buffer_load_dwordx4 v[128:131], v91, s[24:27], s64 offen sc1
    s_mov_b64 exec, -1
Lpc_5:
    s_waitcnt vmcnt(0)
    v_mfma_f32_16x16x32_bf16 v[172:175], v[132:135], v[100:103], 0
    v_sub_u32 v165, s71, v98
    v_and_b32 v165, v165, v92
    v_add3_u32 v164, v100, v101, v102
    v_add3_u32 v164, v164, v103, v104
    v_mfma_f32_16x16x32_bf16 v[172:175], v[136:139], v[104:107], v[172:175]
    v_add3_u32 v164, v164, v105, v106
    v_add3_u32 v164, v164, v107, v108
    v_add3_u32 v164, v164, v109, v110
    v_mfma_f32_16x16x32_bf16 v[172:175], v[140:143], v[108:111], v[172:175]
    v_add3_u32 v164, v164, v111, v112
    v_add3_u32 v164, v164, v113, v114
    v_add3_u32 v164, v164, v115, v116
    v_mfma_f32_16x16x32_bf16 v[172:175], v[144:147], v[112:115], v[172:175]
    v_add3_u32 v164, v164, v117, v118
    v_add3_u32 v164, v164, v119, v120
    v_add3_u32 v164, v164, v121, v122
    v_mfma_f32_16x16x32_bf16 v[172:175], v[148:151], v[116:119], v[172:175]
    v_add3_u32 v164, v164, v123, v124
    v_add3_u32 v164, v164, v125, v126
    v_add3_u32 v164, v164, v127, v128
    v_add3_u32 v164, v164, v129, v130
    v_add3_u32 v164, v164, v131, v165
    v_mfma_f32_16x16x32_bf16 v[172:175], v[152:155], v[120:123], v[172:175]
    s_nop 0
    v_add_u32_dpp v164, v164, v164 quad_perm:[1,0,3,2] row_mask:0xf bank_mask:0xf
    v_mfma_f32_16x16x32_bf16 v[172:175], v[156:159], v[124:127], v[172:175]
    s_nop 0
    v_add_u32_dpp v164, v164, v164 quad_perm:[2,3,0,1] row_mask:0xf bank_mask:0xf
    v_mfma_f32_16x16x32_bf16 v[172:175], v[160:163], v[128:131], v[172:175]
    s_nop 0
    v_add_u32_dpp v164, v164, v164 row_half_mirror row_mask:0xf bank_mask:0xf
    s_nop 1
    v_add_u32_dpp v164, v164, v164 row_mirror row_mask:0xf bank_mask:0xf
    v_cmp_ne_u32 vcc, 0, v164
    s_nop 3
    s_cbranch_vccz Lpd_4
    s_sub_u32 s69, s69, 1
    s_cbranch_scc0 Lp_3
Lpd_4:
    v_mul_f32 v172, v172, v167
    v_mul_f32 v173, v173, v167
    v_mul_f32 v174, v174, v167
    v_mul_f32 v175, v175, v167
    v_cvt_pk_bf16_f32 v172, v172, v173
    v_cvt_pk_bf16_f32 v173, v174, v175
    s_mov_b64 exec, 0xffffffff
    ds_write_b64 v93, v[172:173] offset:5632
    s_mov_b64 exec, -1
    s_waitcnt lgkmcnt(0)
    s_barrier
    ds_read_b128 v[176:179], v23 offset:5632
    ds_read_b128 v[180:183], v23 offset:5888
    ds_read_b128 v[184:187], v23 offset:6144
    ds_read_b128 v[188:191], v23 offset:6400
    s_waitcnt lgkmcnt(3)
    v_mfma_f32_16x16x32_bf16 v[192:195], a[0:3], v[176:179], 0
    v_mfma_f32_16x16x32_bf16 v[196:199], a[4:7], v[176:179], 0
    s_waitcnt lgkmcnt(2)
    v_mfma_f32_16x16x32_bf16 v[192:195], a[8:11], v[180:183], v[192:195]
    v_mfma_f32_16x16x32_bf16 v[196:199], a[12:15], v[180:183], v[196:199]
    s_waitcnt lgkmcnt(1)
    v_mfma_f32_16x16x32_bf16 v[192:195], a[16:19], v[184:187], v[192:195]
    v_mfma_f32_16x16x32_bf16 v[196:199], a[20:23], v[184:187], v[196:199]
    s_waitcnt lgkmcnt(0)
    v_mfma_f32_16x16x32_bf16 v[192:195], a[24:27], v[188:191], v[192:195]
    v_mfma_f32_16x16x32_bf16 v[196:199], a[28:31], v[188:191], v[196:199]
    s_nop 6
    v_and_or_b32 v192, v192, s68, v3
    v_and_or_b32 v193, v193, s68, v3
    v_and_or_b32 v194, v194, s68, v3
    v_and_or_b32 v195, v195, s68, v3
    buffer_store_dwordx4 v[192:195], v37, s[24:27], s65 offen offset:0 sc1
    v_and_or_b32 v196, v196, s68, v3
    v_and_or_b32 v197, v197, s68, v3
    v_and_or_b32 v198, v198, s68, v3
    v_and_or_b32 v199, v199, s68, v3
    buffer_store_dwordx4 v[196:199], v37, s[24:27], s65 offen offset:256 sc1
    s_cmp_ge_u32 s70, 72
    s_cbranch_scc1 L_fin
    v_mul_u32_u24 v150, 1152, v18
    v_and_b32 v4, 1, v17
    v_lshl_add_u32 v150, v4, 3, v150
    s_lshl_b32 s56, s70, 4
    buffer_load_dwordx2 v[148:149], v150, s[4:7], s56 offen
    s_mul_i32 s63, s70, 16512
    s_lshl_b32 s64, s3, 10
    s_add_u32 s63, s63, s64
    s_add_u32 s63, s63, 2097152
    v_add_u32 v140, 0, v2
    v_add_u32 v141, 4096, v2
    v_add_u32 v142, 8192, v2
    v_add_u32 v143, 12288, v2
    v_and_b32 v4, 7, v1
    v_lshlrev_b32 v4, 4, v4
    s_lshl_b32 s64, s3, 7
    v_add_u32 v145, s64, v4
    v_add_u32 v145, 7680, v145
    v_add_u32 v146, 7680, v4
    buffer_load_dwordx4 v[108:111], v140, s[24:27], s63 offen sc1
    buffer_load_dwordx4 v[112:115], v141, s[24:27], s63 offen sc1
    buffer_load_dwordx4 v[116:119], v142, s[24:27], s63 offen sc1
    buffer_load_dwordx4 v[120:123], v143, s[24:27], s63 offen sc1
    s_mov_b32 s69, 40000
Lq_6:
    s_waitcnt vmcnt(0)
    v_bitop3_b32 v156, v108, v109, v110 bitop3:0x7e
    v_bitop3_b32 v157, v108, v111, v3 bitop3:0x7e
    v_bitop3_b32 v156, v156, v157, s67 bitop3:0xa8
    v_cmp_ne_u32 s[36:37], 0, v156
    v_bitop3_b32 v156, v112, v113, v114 bitop3:0x7e
    v_bitop3_b32 v157, v112, v115, v3 bitop3:0x7e
    v_bitop3_b32 v156, v156, v157, s67 bitop3:0xa8
    v_cmp_ne_u32 s[38:39], 0, v156
    v_bitop3_b32 v156, v116, v117, v118 bitop3:0x7e
    v_bitop3_b32 v157, v116, v119, v3 bitop3:0x7e
    v_bitop3_b32 v156, v156, v157, s67 bitop3:0xa8
    v_cmp_ne_u32 s[40:41], 0, v156
    v_bitop3_b32 v156, v120, v121, v122 bitop3:0x7e
    v_bitop3_b32 v157, v120, v123, v3 bitop3:0x7e
    v_bitop3_b32 v156, v156, v157, s67 bitop3:0xa8
    v_cmp_ne_u32 s[42:43], 0, v156
    s_or_b64 vcc, s[36:37], s[38:39]
    s_or_b64 vcc, vcc, s[40:41]
    s_or_b64 vcc, vcc, s[42:43]
    s_nop 0
    s_cbranch_scc0 Lqd_7
    s_mov_b64 exec, s[36:37]
    buffer_load_dwordx4 v[108:111], v140, s[24:27], s63 offen sc1
    s_mov_b64 exec, s[38:39]
    buffer_load_dwordx4 v[112:115], v141, s[24:27], s63 offen sc1
    s_mov_b64 exec, s[40:41]
    buffer_load_dwordx4 v[116:119], v142, s[24:27], s63 offen sc1
    s_mov_b64 exec, s[42:43]
    buffer_load_dwordx4 v[120:123], v143, s[24:27], s63 offen sc1
    s_mov_b64 exec, -1
    s_sub_u32 s69, s69, 1
    s_cbranch_scc0 Lq_6
Lqd_7:
    v_xor_b32 v108, v3, v108
    v_xor_b32 v109, v3, v109
    v_xor_b32 v110, v3, v110
    v_xor_b32 v111, v3, v111
    v_xor_b32 v112, v3, v112
    v_xor_b32 v113, v3, v113
    v_xor_b32 v114, v3, v114
    v_xor_b32 v115, v3, v115
    v_xor_b32 v116, v3, v116
    v_xor_b32 v117, v3, v117
    v_xor_b32 v118, v3, v118
    v_xor_b32 v119, v3, v119
    v_xor_b32 v120, v3, v120
    v_xor_b32 v121, v3, v121
    v_xor_b32 v122, v3, v122
    v_xor_b32 v123, v3, v123
    v_pk_add_f32 v[100:101], v[108:109], v[116:117]
    v_pk_add_f32 v[102:103], v[110:111], v[118:119]
    v_pk_add_f32 v[104:105], v[112:113], v[120:121]
    v_pk_add_f32 v[106:107], v[114:115], v[122:123]
    v_pk_add_f32 v[100:101], v[100:101], v[104:105]
    v_pk_add_f32 v[102:103], v[102:103], v[106:107]
    v_lshlrev_b32 v152, 16, v148
    v_and_b32 v153, 0xffff0000, v148
    v_lshlrev_b32 v154, 16, v149
    v_and_b32 v155, 0xffff0000, v149
    v_add_f32_dpp v100, v100, v100 row_ror:8 row_mask:0xf bank_mask:0xf
    v_add_f32_dpp v101, v101, v101 row_ror:8 row_mask:0xf bank_mask:0xf
    v_add_f32_dpp v102, v102, v102 row_ror:8 row_mask:0xf bank_mask:0xf
    v_add_f32_dpp v103, v103, v103 row_ror:8 row_mask:0xf bank_mask:0xf
    v_mov_b32 v104, v100
    v_mov_b32 v105, v101
    v_mov_b32 v106, v102
    v_mov_b32 v107, v103
    v_permlane16_swap_b32 v100, v104
    v_permlane16_swap_b32 v101, v105
    v_permlane16_swap_b32 v102, v106
    v_permlane16_swap_b32 v103, v107
    v_pk_add_f32 v[100:101], v[100:101], v[104:105]
    v_pk_add_f32 v[102:103], v[102:103], v[106:107]
    v_mov_b32 v104, v100
    v_mov_b32 v105, v101
    v_mov_b32 v106, v102
    v_mov_b32 v107, v103
    v_permlane32_swap_b32 v100, v104
    v_permlane32_swap_b32 v101, v105
    v_permlane32_swap_b32 v102, v106
    v_permlane32_swap_b32 v103, v107
    v_pk_add_f32 v[100:101], v[100:101], v[104:105]
    v_pk_add_f32 v[102:103], v[102:103], v[106:107]
    s_mov_b64 exec, 0xff
    ds_write_b128 v145, v[100:103]
    s_waitcnt lgkmcnt(0)
    s_barrier
    s_cmp_lg_u32 s3, 0
    s_cbranch_scc1 L_fin
    ds_read_b128 v[124:127], v146 offset:0
    ds_read_b128 v[128:131], v146 offset:128
    ds_read_b128 v[132:135], v146 offset:256
    ds_read_b128 v[136:139], v146 offset:384
    s_waitcnt lgkmcnt(0)
    v_pk_add_f32 v[124:125], v[124:125], v[132:133]
    v_pk_add_f32 v[126:127], v[126:127], v[134:135]
    v_pk_add_f32 v[128:129], v[128:129], v[136:137]
    v_pk_add_f32 v[130:131], v[130:131], v[138:139]
    v_pk_add_f32 v[124:125], v[124:125], v[128:129]
    v_pk_add_f32 v[126:127], v[126:127], v[130:131]
    v_pk_add_f32 v[124:125], v[124:125], v[152:153]
    v_pk_add_f32 v[126:127], v[126:127], v[154:155]
    v_cvt_pk_bf16_f32 v148, v124, v125
    v_cvt_pk_bf16_f32 v149, v126, v127
    buffer_store_dwordx2 v[148:149], v150, s[32:35], s56 offen
    s_cmp_lg_u32 s70, 0
    s_cbranch_scc1 L_fin
    s_mov_b64 exec, 1
    v_mov_b32 v4, s71
    buffer_store_dword v4, off, s[24:27], 0 offset:0 sc1
    s_branch L_fin
.p2align 6
L_roleA:
    s_sub_u32 s62, s62, 16
    s_lshl_b32 s70, s61, 4
    s_add_u32 s70, s70, s62
    s_mov_b32 s10, 16777216
    s_mov_b32 s11, 0x20000
    v_lshlrev_b32 v4, 2, v16
    v_xor_b32 v4, v4, v19
    v_lshlrev_b32 v4, 4, v4
    v_lshl_add_u32 v20, v16, 10, v4
    v_xor_b32 v21, 16, v20
    v_xor_b32 v22, 32, v20
    v_xor_b32 v23, 48, v20
    s_lshl_b32 s66, s70, 17
    s_lshl_b32 s69, s3, 8
    s_add_u32 s66, s66, s69
    s_lshl_b32 m0, s3, 15
    s_waitcnt lgkmcnt(0)
    s_mov_b64 s[8:9], s[38:39]
    s_load_dword s60, s[64:65], 0
    buffer_load_dwordx4 v20, s[8:11], s66 offen nt lds
    s_add_u32 m0, m0, 1024
    s_add_u32 s66, s66, 4096
    s_mov_b64 s[20:21], s[46:47]
    s_mov_b32 s22, 4718592
    s_mov_b32 s23, 0x20000
    s_mov_b64 s[12:13], s[54:55]
    s_mov_b32 s14, 5308416
    s_mov_b32 s15, 0x20000
    s_mov_b64 s[24:25], s[64:65]
    s_mov_b32 s26, 9437184
    s_mov_b32 s27, 0x20000
    s_mov_b64 s[32:33], s[56:57]
    s_mov_b32 s34, 4608
    s_mov_b32 s35, 0x20000
    s_mov_b32 s67, 0xfff
    s_mov_b32 s68, 0xfffff000
    s_lshr_b32 s61, s70, 5
    s_lshr_b32 s57, s70, 2
    s_and_b32 s58, s70, 3
    v_and_b32 v24, 31, v1
    v_lshrrev_b32 v25, 5, v1
    v_and_b32 v4, 1, v16
    v_lshlrev_b32 v4, 1, v4
    v_lshrrev_b32 v5, 1, v18
    v_or_b32 v4, v4, v5
    v_lshl_or_b32 v5, v17, 2, v25
    v_xor_b32 v4, v4, v5
    v_lshl_add_u32 v5, v25, 2, v17
    v_lshlrev_b32 v5, 8, v5
    v_and_b32 v6, 1, v18
    v_lshl_add_u32 v5, v6, 3, v5
    s_lshl_b32 s63, s3, 15
    v_add_u32 v5, s63, v5
    v_xor_b32 v6, 0, v4
    v_lshl_add_u32 v52, v6, 4, v5
    v_xor_b32 v6, 2, v4
    v_lshl_add_u32 v53, v6, 4, v5
    v_add_u32 v53, 2048, v53
    v_xor_b32 v6, 4, v4
    v_lshl_add_u32 v54, v6, 4, v5
    v_xor_b32 v6, 6, v4
    v_lshl_add_u32 v55, v6, 4, v5
    v_add_u32 v55, 2048, v55
    v_xor_b32 v6, 8, v4
    v_lshl_add_u32 v56, v6, 4, v5
    v_xor_b32 v6, 10, v4
    v_lshl_add_u32 v57, v6, 4, v5
    v_add_u32 v57, 2048, v57
    v_xor_b32 v6, 12, v4
    v_lshl_add_u32 v58, v6, 4, v5
    v_xor_b32 v6, 14, v4
    v_lshl_add_u32 v59, v6, 4, v5
    v_add_u32 v59, 2048, v59
    v_lshlrev_b32 v73, 4, v24
    v_add_u32 v73, 131072, v73
    s_lshl_b32 s63, s3, 2
    v_add_u32 v72, s63, v73
    v_add_u32 v75, 132096, v2
    s_lshl_b32 s63, s3, 11
    v_add_u32 v74, s63, v75
    s_mul_i32 s52, s3, 2176
    s_lshl_b32 s63, s70, 4
    s_add_u32 s52, s52, s63
    s_add_u32 s52, s52, 524288
    s_mul_i32 s53, s3, 33024
    s_lshl_b32 s63, s70, 8
    s_add_u32 s53, s53, s63
    s_add_u32 s53, s53, 3342336
    v_and_b32 v4, 1, v16
    v_lshl_add_u32 v4, v25, 2, v4
    v_mul_u32_u24 v80, 132096, v4
    v_lshl_add_u32 v80, v19, 4, v80
    v_add_u32 v81, 264192, v80
    v_add_u32 v82, 1056768, v80
    v_add_u32 v83, 1320960, v80
    v_add_u32 v84, 2113536, v80
    v_add_u32 v85, 2377728, v80
    v_add_u32 v86, 3170304, v80
    v_add_u32 v87, 3434496, v80
    v_add_u32 v80, 0, v2
    v_add_u32 v81, 1024, v2
    v_add_u32 v82, 2048, v2
    v_add_u32 v83, 3072, v2
    v_add_u32 v84, 4096, v2
    v_add_u32 v85, 5120, v2
    v_add_u32 v86, 6144, v2
    v_add_u32 v87, 7168, v2
    s_mul_i32 s53, s70, 33024
    s_lshl_b32 s63, s3, 13
    s_add_u32 s53, s53, s63
    s_add_u32 s53, s53, 3342336
    s_mul_i32 s52, s70, 2176
    s_lshl_b32 s63, s3, 9
    s_add_u32 s52, s52, s63
    s_add_u32 s52, s52, 524288
    v_and_b32 v5, 1, v1
    v_lshl_add_u32 v4, v5, 4, v4
    v_lshrrev_b32 v5, 1, v17
    v_lshl_add_u32 v4, v5, 3, v4
    v_and_b32 v5, 1, v17
    v_lshl_add_u32 v4, v5, 1, v4
    v_mul_u32_u24 v88, 16, v4
    v_lshlrev_b32 v76, 2, v4
    v_and_b32 v5, 2, v1
    v_lshl_add_u32 v88, v5, 28, v88
    s_and_b32 s63, s3, 1
    s_lshl_b32 s63, s63, 2
    v_or_b32 v4, s63, v16
    v_lshlrev_b32 v4, 1, v4
    v_xor_b32 v4, v4, v19
    v_lshlrev_b32 v4, 4, v4
    v_mul_u32_u24 v26, 1152, v16
    v_add_u32 v26, v26, v4
    s_mul_i32 s65, s57, 147456
    s_mul_i32 s64, s3, 4608
    s_add_u32 s17, s65, s64
    s_lshl_b32 s64, s58, 8
    s_add_u32 s17, s17, s64
    v_lshrrev_b32 v4, 3, v1
    v_mul_u32_u24 v30, 1152, v4
    v_and_b32 v4, 7, v1
    v_lshl_add_u32 v27, v4, 4, v30
    s_mul_i32 s63, s3, 9216
    s_add_u32 s18, s63, s65
    s_add_u32 s18, s18, 1024
    s_cmp_eq_u32 s58, 3
    s_cselect_b32 s18, s18, 0x70000000
    v_lshlrev_b32 v5, 1, v16
    v_xor_b32 v4, v4, v5
    v_lshl_add_u32 v30, v4, 4, v30
    s_lshl_b32 s63, s3, 5
    v_xor_b32 v28, s63, v2
    v_xor_b32 v29, 128, v28
    s_mul_i32 s19, s70, 41472
    s_mul_i32 s63, s3, 1152
    s_add_u32 s16, s19, s63
    s_lshl_b32 s59, s3, 10
    v_lshl_or_b32 v4, v18, 2, v17
    v_xor_b32 v4, v4, v25
    s_lshl_b32 s63, s3, 13
    v_lshlrev_b32 v5, 8, v24
    v_add_u32 v5, s63, v5
    v_xor_b32 v6, 0, v4
    v_lshl_add_u32 v32, v6, 4, v5
    v_add_u32 v40, 0x10000, v32
    v_xor_b32 v6, 2, v4
    v_lshl_add_u32 v33, v6, 4, v5
    v_add_u32 v41, 0x10000, v33
    v_xor_b32 v6, 4, v4
    v_lshl_add_u32 v34, v6, 4, v5
    v_add_u32 v42, 0x10000, v34
    v_xor_b32 v6, 6, v4
    v_lshl_add_u32 v35, v6, 4, v5
    v_add_u32 v43, 0x10000, v35
    v_xor_b32 v6, 8, v4
    v_lshl_add_u32 v36, v6, 4, v5
    v_add_u32 v44, 0x10000, v36
    v_xor_b32 v6, 10, v4
    v_lshl_add_u32 v37, v6, 4, v5
    v_add_u32 v45, 0x10000, v37
    v_xor_b32 v6, 12, v4
    v_lshl_add_u32 v38, v6, 4, v5
    v_add_u32 v46, 0x10000, v38
    v_xor_b32 v6, 14, v4
    v_lshl_add_u32 v39, v6, 4, v5
    v_add_u32 v47, 0x10000, v39
    s_waitcnt lgkmcnt(0)
    s_add_u32 s71, s60, 1
    s_and_b32 s60, s71, s67
    v_mov_b32 v3, s60
    v_lshlrev_b32 v4, 1, v25
    v_xor_b32 v4, v4, v24
    v_lshlrev_b32 v4, 4, v4
    v_lshl_add_u32 v4, v25, 9, v4
    v_add_u32 v48, 131072, v4
    v_xor_b32 v49, 64, v48
    v_lshrrev_b32 v4, 2, v1
    v_lshlrev_b32 v5, 1, v18
    v_xor_b32 v4, v4, v5
    v_lshlrev_b32 v4, 4, v4
    v_lshl_add_u32 v60, v18, 9, v4
    s_lshl_b32 s63, s3, 13
    s_add_u32 s63, s63, 131072
    v_add_u32 v60, s63, v60
    v_mov_b32 v4, s71
    v_cmp_eq_u32 vcc, 0, v18
    s_nop 1
    v_cndmask_b32 v61, 0, v4, vcc
    s_lshl_b32 s64, s61, 15
    s_lshl_b32 s63, s3, 13
    s_add_u32 s64, s64, s63
    s_add_u32 s64, s64, 131072
    s_add_u32 s56, s64, 4096
    s_lshl_b32 s65, s61, 11
    s_lshl_b32 s63, s3, 9
    s_add_u32 s65, s65, s63
    s_add_u32 s65, s65, 4096
    v_lshrrev_b32 v140, 2, v1
    v_lshlrev_b32 v140, 5, v140
    s_lshl_b32 s63, s71, 3
    s_sub_u32 s63, 0, s63
    v_mov_b32 v152, s63
    s_waitcnt vmcnt(0)
    buffer_load_dwordx4 v21, s[8:11], s66 offen nt lds
    s_add_u32 m0, m0, 1024
    s_add_u32 s66, s66, 4096
    s_waitcnt vmcnt(0)
    buffer_load_dwordx4 v22, s[8:11], s66 offen nt lds
    s_add_u32 m0, m0, 1024
    s_add_u32 s66, s66, 4096
    s_waitcnt vmcnt(11)
    buffer_load_dwordx4 v23, s[8:11], s66 offen nt lds
    s_add_u32 m0, m0, 1024
    s_add_u32 s66, s66, 4096
    s_waitcnt vmcnt(11)
    buffer_load_dwordx4 v20, s[8:11], s66 offen nt lds
    s_add_u32 m0, m0, 1024
    s_add_u32 s66, s66, 4096
    s_waitcnt vmcnt(11)
    buffer_load_dwordx4 v21, s[8:11], s66 offen nt lds
    s_add_u32 m0, m0, 1024
    s_add_u32 s66, s66, 4096
    s_waitcnt vmcnt(11)
    buffer_load_dwordx4 v22, s[8:11], s66 offen nt lds
    s_add_u32 m0, m0, 1024
    s_add_u32 s66, s66, 4096
    s_waitcnt vmcnt(11)
    buffer_load_dwordx4 v23, s[8:11], s66 offen nt lds
    s_add_u32 m0, m0, 1024
    s_add_u32 s66, s66, 4096
    s_waitcnt vmcnt(11)
    buffer_load_dwordx4 v20, s[8:11], s66 offen nt lds
    s_add_u32 m0, m0, 1024
    s_add_u32 s66, s66, 4096
    s_waitcnt vmcnt(11)
    buffer_load_dwordx4 v21, s[8:11], s66 offen nt lds
    s_add_u32 m0, m0, 1024
    s_add_u32 s66, s66, 4096
    s_waitcnt vmcnt(11)
    buffer_load_dwordx4 v22, s[8:11], s66 offen nt lds
    s_add_u32 m0, m0, 1024
    s_add_u32 s66, s66, 4096
    s_waitcnt vmcnt(11)
    buffer_load_dwordx4 v23, s[8:11], s66 offen nt lds
    s_add_u32 m0, m0, 1024
    s_add_u32 s66, s66, 4096
    s_waitcnt vmcnt(11)
    buffer_load_dwordx4 v20, s[8:11], s66 offen nt lds
    s_add_u32 m0, m0, 1024
    s_add_u32 s66, s66, 4096
    s_waitcnt vmcnt(11)
    buffer_load_dwordx4 v21, s[8:11], s66 offen nt lds
    s_add_u32 m0, m0, 1024
    s_add_u32 s66, s66, 4096
    s_waitcnt vmcnt(11)
    buffer_load_dwordx4 v22, s[8:11], s66 offen nt lds
    s_add_u32 m0, m0, 1024
    s_add_u32 s66, s66, 4096
    s_waitcnt vmcnt(11)
    buffer_load_dwordx4 v23, s[8:11], s66 offen nt lds
    s_add_u32 m0, m0, 1024
    s_add_u32 s66, s66, 4096
    ds_read_b64_tr_b16 a[0:1], v52 offset:0
    ds_read_b64_tr_b16 a[2:3], v53 offset:0
    ds_read_b64_tr_b16 a[4:5], v54 offset:0
    ds_read_b64_tr_b16 a[6:7], v55 offset:0
    ds_read_b64_tr_b16 a[8:9], v56 offset:0
    ds_read_b64_tr_b16 a[10:11], v57 offset:0
    ds_read_b64_tr_b16 a[12:13], v58 offset:0
    ds_read_b64_tr_b16 a[14:15], v59 offset:0
    s_waitcnt vmcnt(11)
    buffer_load_dwordx4 v20, s[8:11], s66 offen nt lds
    s_add_u32 m0, m0, 1024
    s_add_u32 s66, s66, 4096
    s_waitcnt vmcnt(11)
    buffer_load_dwordx4 v21, s[8:11], s66 offen nt lds
    s_add_u32 m0, m0, 1024
    s_add_u32 s66, s66, 4096
    s_waitcnt vmcnt(11)
    buffer_load_dwordx4 v22, s[8:11], s66 offen nt lds
    s_add_u32 m0, m0, 1024
    s_add_u32 s66, s66, 4096
    s_waitcnt vmcnt(11)
    buffer_load_dwordx4 v23, s[8:11], s66 offen nt lds
    s_add_u32 m0, m0, 1024
    s_add_u32 s66, s66, 4096
    ds_read_b64_tr_b16 a[16:17], v52 offset:4096
    ds_read_b64_tr_b16 a[18:19], v53 offset:4096
    ds_read_b64_tr_b16 a[20:21], v54 offset:4096
    ds_read_b64_tr_b16 a[22:23], v55 offset:4096
    ds_read_b64_tr_b16 a[24:25], v56 offset:4096
    ds_read_b64_tr_b16 a[26:27], v57 offset:4096
    ds_read_b64_tr_b16 a[28:29], v58 offset:4096
    ds_read_b64_tr_b16 a[30:31], v59 offset:4096
    s_waitcnt vmcnt(11)
    buffer_load_dwordx4 v20, s[8:11], s66 offen nt lds
    s_add_u32 m0, m0, 1024
    s_add_u32 s66, s66, 4096
    s_waitcnt vmcnt(11)
    buffer_load_dwordx4 v21, s[8:11], s66 offen nt lds
    s_add_u32 m0, m0, 1024
    s_add_u32 s66, s66, 4096
    s_waitcnt vmcnt(11)
    buffer_load_dwordx4 v22, s[8:11], s66 offen nt lds
    s_add_u32 m0, m0, 1024
    s_add_u32 s66, s66, 4096
    s_waitcnt vmcnt(11)
    buffer_load_dwordx4 v23, s[8:11], s66 offen nt lds
    s_add_u32 m0, m0, 1024
    s_add_u32 s66, s66, 4096
    ds_read_b64_tr_b16 a[32:33], v52 offset:8192
    ds_read_b64_tr_b16 a[34:35], v53 offset:8192
    ds_read_b64_tr_b16 a[36:37], v54 offset:8192
    ds_read_b64_tr_b16 a[38:39], v55 offset:8192
    ds_read_b64_tr_b16 a[40:41], v56 offset:8192
    ds_read_b64_tr_b16 a[42:43], v57 offset:8192
    ds_read_b64_tr_b16 a[44:45], v58 offset:8192
    ds_read_b64_tr_b16 a[46:47], v59 offset:8192
    s_waitcnt vmcnt(11)
    buffer_load_dwordx4 v20, s[8:11], s66 offen nt lds
    s_add_u32 m0, m0, 1024
    s_add_u32 s66, s66, 4096
    s_waitcnt vmcnt(11)
    buffer_load_dwordx4 v21, s[8:11], s66 offen nt lds
    s_add_u32 m0, m0, 1024
    s_add_u32 s66, s66, 4096
    s_waitcnt vmcnt(11)
    buffer_load_dwordx4 v22, s[8:11], s66 offen nt lds
    s_add_u32 m0, m0, 1024
    s_add_u32 s66, s66, 4096
    s_waitcnt vmcnt(11)
    buffer_load_dwordx4 v23, s[8:11], s66 offen nt lds
    s_add_u32 m0, m0, 1024
    s_add_u32 s66, s66, 4096
    ds_read_b64_tr_b16 a[48:49], v52 offset:12288
    ds_read_b64_tr_b16 a[50:51], v53 offset:12288
    ds_read_b64_tr_b16 a[52:53], v54 offset:12288
    ds_read_b64_tr_b16 a[54:55], v55 offset:12288
    ds_read_b64_tr_b16 a[56:57], v56 offset:12288
    ds_read_b64_tr_b16 a[58:59], v57 offset:12288
    ds_read_b64_tr_b16 a[60:61], v58 offset:12288
    ds_read_b64_tr_b16 a[62:63], v59 offset:12288
    s_waitcnt vmcnt(11)
    buffer_load_dwordx4 v20, s[8:11], s66 offen nt lds
    s_add_u32 m0, m0, 1024
    s_add_u32 s66, s66, 4096
    s_waitcnt vmcnt(11)
    buffer_load_dwordx4 v21, s[8:11], s66 offen nt lds
    s_add_u32 m0, m0, 1024
    s_add_u32 s66, s66, 4096
    s_waitcnt vmcnt(11)
    buffer_load_dwordx4 v22, s[8:11], s66 offen nt lds
    s_add_u32 m0, m0, 1024
    s_add_u32 s66, s66, 4096
    s_waitcnt vmcnt(11)
    buffer_load_dwordx4 v23, s[8:11], s66 offen nt lds
    ds_read_b64_tr_b16 a[64:65], v52 offset:16384
    ds_read_b64_tr_b16 a[66:67], v53 offset:16384
    ds_read_b64_tr_b16 a[68:69], v54 offset:16384
    ds_read_b64_tr_b16 a[70:71], v55 offset:16384
    ds_read_b64_tr_b16 a[72:73], v56 offset:16384
    ds_read_b64_tr_b16 a[74:75], v57 offset:16384
    ds_read_b64_tr_b16 a[76:77], v58 offset:16384
    ds_read_b64_tr_b16 a[78:79], v59 offset:16384
    s_waitcnt vmcnt(8)
    ds_read_b64_tr_b16 a[80:81], v52 offset:20480
    ds_read_b64_tr_b16 a[82:83], v53 offset:20480
    ds_read_b64_tr_b16 a[84:85], v54 offset:20480
    ds_read_b64_tr_b16 a[86:87], v55 offset:20480
    ds_read_b64_tr_b16 a[88:89], v56 offset:20480
    ds_read_b64_tr_b16 a[90:91], v57 offset:20480
    ds_read_b64_tr_b16 a[92:93], v58 offset:20480
    ds_read_b64_tr_b16 a[94:95], v59 offset:20480
    s_waitcnt vmcnt(4)
    ds_read_b64_tr_b16 a[96:97], v52 offset:24576
    ds_read_b64_tr_b16 a[98:99], v53 offset:24576
    ds_read_b64_tr_b16 a[100:101], v54 offset:24576
    ds_read_b64_tr_b16 a[102:103], v55 offset:24576
    ds_read_b64_tr_b16 a[104:105], v56 offset:24576
    ds_read_b64_tr_b16 a[106:107], v57 offset:24576
    ds_read_b64_tr_b16 a[108:109], v58 offset:24576
    ds_read_b64_tr_b16 a[110:111], v59 offset:24576
    s_waitcnt vmcnt(0)
    ds_read_b64_tr_b16 a[112:113], v52 offset:28672
    ds_read_b64_tr_b16 a[114:115], v53 offset:28672
    ds_read_b64_tr_b16 a[116:117], v54 offset:28672
    ds_read_b64_tr_b16 a[118:119], v55 offset:28672
    ds_read_b64_tr_b16 a[120:121], v56 offset:28672
    ds_read_b64_tr_b16 a[122:123], v57 offset:28672
    ds_read_b64_tr_b16 a[124:125], v58 offset:28672
    ds_read_b64_tr_b16 a[126:127], v59 offset:28672
    buffer_load_dwordx4 v[100:103], v2, s[24:27], s64 offen offset:0
    buffer_load_dwordx4 v[104:107], v2, s[24:27], s64 offen offset:1024
    buffer_load_dwordx4 v[108:111], v2, s[24:27], s64 offen offset:2048
    buffer_load_dwordx4 v[112:115], v2, s[24:27], s64 offen offset:3072
    buffer_load_dwordx4 v[116:119], v2, s[24:27], s56 offen offset:0
    buffer_load_dwordx4 v[120:123], v2, s[24:27], s56 offen offset:1024
    buffer_load_dwordx4 v[124:127], v2, s[24:27], s56 offen offset:2048
    buffer_load_dwordx4 v[128:131], v2, s[24:27], s56 offen offset:3072
    buffer_load_dwordx4 v[132:135], v140, s[24:27], s65 offen offset:0
    buffer_load_dwordx4 v[136:139], v140, s[24:27], s65 offen offset:16
    s_waitcnt vmcnt(0)
    ds_write_b128 v60, v[100:103] offset:0
    v_add3_u32 v96, v100, v101, v102
    v_add3_u32 v96, v96, v103, v104
    ds_write_b128 v60, v[104:107] offset:256
    v_add3_u32 v96, v96, v105, v106
    v_add3_u32 v96, v96, v107, v108
    ds_write_b128 v60, v[108:111] offset:2048
    v_add3_u32 v96, v96, v109, v110
    v_add3_u32 v96, v96, v111, v112
    ds_write_b128 v60, v[112:115] offset:2304
    v_add3_u32 v96, v96, v113, v114
    v_add3_u32 v96, v96, v115, v116
    ds_write_b128 v60, v[116:119] offset:4096
    v_add3_u32 v96, v96, v117, v118
    v_add3_u32 v96, v96, v119, v120
    ds_write_b128 v60, v[120:123] offset:4352
    v_add3_u32 v96, v96, v121, v122
    v_add3_u32 v96, v96, v123, v124
    ds_write_b128 v60, v[124:127] offset:6144
    v_add3_u32 v96, v96, v125, v126
    v_add3_u32 v96, v96, v127, v128
    ds_write_b128 v60, v[128:131] offset:6400
    v_add3_u32 v96, v96, v129, v130
    v_add_u32 v96, v131, v96
    v_add3_u32 v97, v132, v133, v134
    v_add3_u32 v97, v97, v135, v136
    v_add_u32_dpp v96, v96, v96 quad_perm:[1,0,3,2] row_mask:0xf bank_mask:0xf
    v_add3_u32 v97, v97, v137, v138
    v_add3_u32 v97, v97, v139, v152
    v_add_u32_dpp v96, v96, v96 quad_perm:[2,3,0,1] row_mask:0xf bank_mask:0xf
    v_cmp_ne_u32 vcc, v96, v97
    s_nop 0
    s_mov_b64 s[36:37], vcc
    s_mov_b32 s69, 40000
    s_cmp_eq_u64 s[36:37], 0
    s_cbranch_scc1 Lpd_9
Lp_8:
    v_add3_u32 v144, v100, v101, v102
    v_add3_u32 v144, v144, v103, v61
    v_add3_u32 v145, v104, v105, v106
    v_add3_u32 v145, v145, v107, v61
    v_add3_u32 v146, v108, v109, v110
    v_add3_u32 v146, v146, v111, v61
    v_add3_u32 v147, v112, v113, v114
    v_add3_u32 v147, v147, v115, v61
    v_add3_u32 v148, v116, v117, v118
    v_add3_u32 v148, v148, v119, v61
    v_add3_u32 v149, v120, v121, v122
    v_add3_u32 v149, v149, v123, v61
    v_add3_u32 v150, v124, v125, v126
    v_add3_u32 v150, v150, v127, v61
    v_add3_u32 v151, v128, v129, v130
    v_add3_u32 v151, v151, v131, v61
    v_add_u32_dpp v144, v144, v144 quad_perm:[1,0,3,2] row_mask:0xf bank_mask:0xf
    v_add_u32_dpp v145, v145, v145 quad_perm:[1,0,3,2] row_mask:0xf bank_mask:0xf
    v_add_u32_dpp v146, v146, v146 quad_perm:[1,0,3,2] row_mask:0xf bank_mask:0xf
    v_add_u32_dpp v147, v147, v147 quad_perm:[1,0,3,2] row_mask:0xf bank_mask:0xf
    v_add_u32_dpp v148, v148, v148 quad_perm:[1,0,3,2] row_mask:0xf bank_mask:0xf
    v_add_u32_dpp v149, v149, v149 quad_perm:[1,0,3,2] row_mask:0xf bank_mask:0xf
    v_add_u32_dpp v150, v150, v150 quad_perm:[1,0,3,2] row_mask:0xf bank_mask:0xf
    v_add_u32_dpp v151, v151, v151 quad_perm:[1,0,3,2] row_mask:0xf bank_mask:0xf
    v_add_u32_dpp v144, v144, v144 quad_perm:[2,3,0,1] row_mask:0xf bank_mask:0xf
    v_add_u32_dpp v145, v145, v145 quad_perm:[2,3,0,1] row_mask:0xf bank_mask:0xf
    v_add_u32_dpp v146, v146, v146 quad_perm:[2,3,0,1] row_mask:0xf bank_mask:0xf
    v_add_u32_dpp v147, v147, v147 quad_perm:[2,3,0,1] row_mask:0xf bank_mask:0xf
    v_add_u32_dpp v148, v148, v148 quad_perm:[2,3,0,1] row_mask:0xf bank_mask:0xf
    v_add_u32_dpp v149, v149, v149 quad_perm:[2,3,0,1] row_mask:0xf bank_mask:0xf
    v_add_u32_dpp v150, v150, v150 quad_perm:[2,3,0,1] row_mask:0xf bank_mask:0xf
    v_add_u32_dpp v151, v151, v151 quad_perm:[2,3,0,1] row_mask:0xf bank_mask:0xf
    v_cmp_ne_u32 s[36:37], v144, v132
    v_cmp_ne_u32 s[38:39], v145, v133
    v_cmp_ne_u32 s[40:41], v146, v134
    v_cmp_ne_u32 s[42:43], v147, v135
    v_cmp_ne_u32 s[44:45], v148, v136
    v_cmp_ne_u32 s[46:47], v149, v137
    v_cmp_ne_u32 s[48:49], v150, v138
    v_cmp_ne_u32 s[50:51], v151, v139
    s_mov_b64 exec, s[36:37]
    buffer_load_dwordx4 v[100:103], v2, s[24:27], s64 offen offset:0 sc1
    s_mov_b64 exec, s[38:39]
    buffer_load_dwordx4 v[104:107], v2, s[24:27], s64 offen offset:1024 sc1
    s_mov_b64 exec, s[40:41]
    buffer_load_dwordx4 v[108:111], v2, s[24:27], s64 offen offset:2048 sc1
    s_mov_b64 exec, s[42:43]
    buffer_load_dwordx4 v[112:115], v2, s[24:27], s64 offen offset:3072 sc1
    s_mov_b64 exec, s[44:45]
    buffer_load_dwordx4 v[116:119], v2, s[24:27], s56 offen offset:0 sc1
    s_mov_b64 exec, s[46:47]
    buffer_load_dwordx4 v[120:123], v2, s[24:27], s56 offen offset:1024 sc1
    s_mov_b64 exec, s[48:49]
    buffer_load_dwordx4 v[124:127], v2, s[24:27], s56 offen offset:2048 sc1
    s_mov_b64 exec, s[50:51]
    buffer_load_dwordx4 v[128:131], v2, s[24:27], s56 offen offset:3072 sc1
    s_mov_b64 exec, -1
    buffer_load_dwordx4 v[132:135], v140, s[24:27], s65 offen offset:0 sc1
    buffer_load_dwordx4 v[136:139], v140, s[24:27], s65 offen offset:16 sc1
Lpc_10:
    s_waitcnt vmcnt(0)
    ds_write_b128 v60, v[100:103] offset:0
    v_add3_u32 v96, v100, v101, v102
    v_add3_u32 v96, v96, v103, v104
    ds_write_b128 v60, v[104:107] offset:256
    v_add3_u32 v96, v96, v105, v106
    v_add3_u32 v96, v96, v107, v108
    ds_write_b128 v60, v[108:111] offset:2048
    v_add3_u32 v96, v96, v109, v110
    v_add3_u32 v96, v96, v111, v112
    ds_write_b128 v60, v[112:115] offset:2304
    v_add3_u32 v96, v96, v113, v114
    v_add3_u32 v96, v96, v115, v116
    ds_write_b128 v60, v[116:119] offset:4096
    v_add3_u32 v96, v96, v117, v118
    v_add3_u32 v96, v96, v119, v120
    ds_write_b128 v60, v[120:123] offset:4352
    v_add3_u32 v96, v96, v121, v122
    v_add3_u32 v96, v96, v123, v124
    ds_write_b128 v60, v[124:127] offset:6144
    v_add3_u32 v96, v96, v125, v126
    v_add3_u32 v96, v96, v127, v128
    ds_write_b128 v60, v[128:131] offset:6400
    v_add3_u32 v96, v96, v129, v130
    v_add_u32 v96, v131, v96
    v_add3_u32 v97, v132, v133, v134
    v_add3_u32 v97, v97, v135, v136
    v_add_u32_dpp v96, v96, v96 quad_perm:[1,0,3,2] row_mask:0xf bank_mask:0xf
    v_add3_u32 v97, v97, v137, v138
    v_add3_u32 v97, v97, v139, v152
    v_add_u32_dpp v96, v96, v96 quad_perm:[2,3,0,1] row_mask:0xf bank_mask:0xf
    v_cmp_ne_u32 vcc, v96, v97
    s_nop 3
    s_cbranch_vccz Lpd_9
    s_sub_u32 s69, s69, 1
    s_cbranch_scc0 Lp_8
Lpd_9:
    s_waitcnt lgkmcnt(0)
    s_barrier
    ds_read_b128 v[112:115], v32 offset:0
    ds_read_b128 v[128:131], v48 offset:0
    ds_read_b128 v[116:119], v33 offset:0
    ds_read_b128 v[132:135], v49 offset:1024
    ds_read_b128 v[120:123], v34 offset:0
    ds_read_b128 v[136:139], v48 offset:2048
    ds_read_b128 v[124:127], v35 offset:0
    ds_read_b128 v[140:143], v49 offset:3072
    s_waitcnt lgkmcnt(6)
    v_mfma_f32_32x32x16_bf16 v[96:111], v[112:115], v[128:131], 0
    buffer_load_dwordx4 a[128:131], v28, s[12:15], s16 offen nt
    s_add_u32 s16, s16, 4608
    ds_read_b128 v[112:115], v36 offset:0
    ds_read_b128 v[128:131], v48 offset:4096
    s_waitcnt lgkmcnt(6)
    v_mfma_f32_32x32x16_bf16 v[96:111], v[116:119], v[132:135], v[96:111]
    buffer_load_dwordx4 a[132:135], v29, s[12:15], s16 offen nt
    s_add_u32 s16, s16, 4608
    ds_read_b128 v[116:119], v37 offset:0
    ds_read_b128 v[132:135], v49 offset:5120
    s_waitcnt lgkmcnt(6)
    v_mfma_f32_32x32x16_bf16 v[96:111], v[120:123], v[136:139], v[96:111]
    buffer_load_dwordx4 a[136:139], v28, s[12:15], s16 offen nt
    s_add_u32 s16, s16, 4608
    ds_read_b128 v[120:123], v38 offset:0
    ds_read_b128 v[136:139], v48 offset:6144
    s_waitcnt lgkmcnt(6)
    v_mfma_f32_32x32x16_bf16 v[96:111], v[124:127], v[140:143], v[96:111]
    buffer_load_dwordx4 a[140:143], v29, s[12:15], s16 offen nt
    s_add_u32 s16, s16, 4608
    ds_read_b128 v[124:127], v39 offset:0
    ds_read_b128 v[140:143], v49 offset:7168
    s_waitcnt lgkmcnt(6)
    v_mfma_f32_32x32x16_bf16 v[96:111], v[112:115], v[128:131], v[96:111]
    buffer_load_dwordx4 a[144:147], v28, s[12:15], s16 offen nt
    s_add_u32 s16, s16, 4608
    ds_read_b128 v[112:115], v32 offset:32768
    ds_read_b128 v[128:131], v48 offset:8192
    s_waitcnt lgkmcnt(6)
    v_mfma_f32_32x32x16_bf16 v[96:111], v[116:119], v[132:135], v[96:111]
    buffer_load_dwordx4 a[148:151], v29, s[12:15], s16 offen nt
    s_add_u32 s16, s16, 4608
    ds_read_b128 v[116:119], v33 offset:32768
    ds_read_b128 v[132:135], v49 offset:9216
    s_waitcnt lgkmcnt(6)
    v_mfma_f32_32x32x16_bf16 v[96:111], v[120:123], v[136:139], v[96:111]
    buffer_load_dwordx4 a[152:155], v28, s[12:15], s16 offen nt
    s_add_u32 s16, s16, 4608
    ds_read_b128 v[120:123], v34 offset:32768
    ds_read_b128 v[136:139], v48 offset:10240
    s_waitcnt lgkmcnt(6)
    v_mfma_f32_32x32x16_bf16 v[96:111], v[124:127], v[140:143], v[96:111]
    buffer_load_dwordx4 a[156:159], v29, s[12:15], s16 offen nt
    s_add_u32 s16, s16, 4608
    ds_read_b128 v[124:127], v35 offset:32768
    ds_read_b128 v[140:143], v49 offset:11264
    s_waitcnt lgkmcnt(6)
    v_mfma_f32_32x32x16_bf16 v[96:111], v[112:115], v[128:131], v[96:111]
    ds_read_b128 v[112:115], v36 offset:32768
    ds_read_b128 v[128:131], v48 offset:12288
    s_waitcnt lgkmcnt(6)
    v_mfma_f32_32x32x16_bf16 v[96:111], v[116:119], v[132:135], v[96:111]
    ds_read_b128 v[116:119], v37 offset:32768
    ds_read_b128 v[132:135], v49 offset:13312
    s_waitcnt lgkmcnt(6)
    v_mfma_f32_32x32x16_bf16 v[96:111], v[120:123], v[136:139], v[96:111]
    ds_read_b128 v[120:123], v38 offset:32768
    ds_read_b128 v[136:139], v48 offset:14336
    s_waitcnt lgkmcnt(6)
    v_mfma_f32_32x32x16_bf16 v[96:111], v[124:127], v[140:143], v[96:111]
    ds_read_b128 v[124:127], v39 offset:32768
    ds_read_b128 v[140:143], v49 offset:15360
    s_waitcnt lgkmcnt(6)
    v_mfma_f32_32x32x16_bf16 v[96:111], v[112:115], v[128:131], v[96:111]
    ds_read_b128 v[112:115], v40 offset:0
    ds_read_b128 v[128:131], v48 offset:16384
    s_waitcnt lgkmcnt(6)
    v_mfma_f32_32x32x16_bf16 v[96:111], v[116:119], v[132:135], v[96:111]
    ds_read_b128 v[116:119], v41 offset:0
    ds_read_b128 v[132:135], v49 offset:17408
    s_waitcnt lgkmcnt(6)
    v_mfma_f32_32x32x16_bf16 v[96:111], v[120:123], v[136:139], v[96:111]
    ds_read_b128 v[120:123], v42 offset:0
    ds_read_b128 v[136:139], v48 offset:18432
    s_waitcnt lgkmcnt(6)
    v_mfma_f32_32x32x16_bf16 v[96:111], v[124:127], v[140:143], v[96:111]
    ds_read_b128 v[124:127], v43 offset:0
    ds_read_b128 v[140:143], v49 offset:19456
    s_waitcnt lgkmcnt(6)
    v_mfma_f32_32x32x16_bf16 v[96:111], v[112:115], v[128:131], v[96:111]
    ds_read_b128 v[112:115], v44 offset:0
    ds_read_b128 v[128:131], v48 offset:20480
    s_waitcnt lgkmcnt(6)
    v_mfma_f32_32x32x16_bf16 v[96:111], v[116:119], v[132:135], v[96:111]
    ds_read_b128 v[116:119], v45 offset:0
    ds_read_b128 v[132:135], v49 offset:21504
    s_waitcnt lgkmcnt(6)
    v_mfma_f32_32x32x16_bf16 v[96:111], v[120:123], v[136:139], v[96:111]
    ds_read_b128 v[120:123], v46 offset:0
    ds_read_b128 v[136:139], v48 offset:22528
    s_waitcnt lgkmcnt(6)
    v_mfma_f32_32x32x16_bf16 v[96:111], v[124:127], v[140:143], v[96:111]
    ds_read_b128 v[124:127], v47 offset:0
    ds_read_b128 v[140:143], v49 offset:23552
    s_waitcnt lgkmcnt(6)
    v_mfma_f32_32x32x16_bf16 v[96:111], v[112:115], v[128:131], v[96:111]
    ds_read_b128 v[112:115], v40 offset:32768
    ds_read_b128 v[128:131], v48 offset:24576
    s_waitcnt lgkmcnt(6)
    v_mfma_f32_32x32x16_bf16 v[96:111], v[116:119], v[132:135], v[96:111]
    ds_read_b128 v[116:119], v41 offset:32768
    ds_read_b128 v[132:135], v49 offset:25600
    s_waitcnt lgkmcnt(6)
    v_mfma_f32_32x32x16_bf16 v[96:111], v[120:123], v[136:139], v[96:111]
    ds_read_b128 v[120:123], v42 offset:32768
    ds_read_b128 v[136:139], v48 offset:26624
    s_waitcnt lgkmcnt(6)
    v_mfma_f32_32x32x16_bf16 v[96:111], v[124:127], v[140:143], v[96:111]
    ds_read_b128 v[124:127], v43 offset:32768
    ds_read_b128 v[140:143], v49 offset:27648
    s_waitcnt lgkmcnt(6)
    v_mfma_f32_32x32x16_bf16 v[96:111], v[112:115], v[128:131], v[96:111]
    ds_read_b128 v[112:115], v44 offset:32768
    ds_read_b128 v[128:131], v48 offset:28672
    s_waitcnt lgkmcnt(6)
    v_mfma_f32_32x32x16_bf16 v[96:111], v[116:119], v[132:135], v[96:111]
    ds_read_b128 v[116:119], v45 offset:32768
    ds_read_b128 v[132:135], v49 offset:29696
    s_waitcnt lgkmcnt(6)
    v_mfma_f32_32x32x16_bf16 v[96:111], v[120:123], v[136:139], v[96:111]
    ds_read_b128 v[120:123], v46 offset:32768
    ds_read_b128 v[136:139], v48 offset:30720
    s_waitcnt lgkmcnt(6)
    v_mfma_f32_32x32x16_bf16 v[96:111], v[124:127], v[140:143], v[96:111]
    ds_read_b128 v[124:127], v47 offset:32768
    ds_read_b128 v[140:143], v49 offset:31744
    s_waitcnt lgkmcnt(6)
    v_mfma_f32_32x32x16_bf16 v[96:111], v[112:115], v[128:131], v[96:111]
    s_waitcnt lgkmcnt(4)
    v_mfma_f32_32x32x16_bf16 v[96:111], v[116:119], v[132:135], v[96:111]
    s_waitcnt lgkmcnt(2)
    v_mfma_f32_32x32x16_bf16 v[96:111], v[120:123], v[136:139], v[96:111]
    s_waitcnt lgkmcnt(0)
    v_mfma_f32_32x32x16_bf16 v[96:111], v[124:127], v[140:143], v[96:111]
    s_barrier
    s_mov_b32 s64, 0x3e0293ee
    s_nop 9
    v_max3_f32 v62, v96, v97, v98
    v_max3_f32 v62, v62, v99, v100
    v_max3_f32 v62, v62, v101, v102
    v_max3_f32 v62, v62, v103, v104
    v_max3_f32 v62, v62, v105, v106
    v_max3_f32 v62, v62, v107, v108
    v_max3_f32 v62, v62, v109, v110
    v_max_f32 v62, v62, v111
    v_mov_b32 v63, v62
    s_nop 1
    v_permlane32_swap_b32 v62, v63
    v_max_f32 v62, v62, v63
    ds_write_b32 v72, v62
    s_waitcnt lgkmcnt(0)
    s_barrier
    ds_read_b128 v[68:71], v73
    s_waitcnt lgkmcnt(0)
    v_max3_f32 v62, v68, v69, v70
    v_max_f32 v62, v62, v71
    v_mul_f32 v92, s64, v62
    v_fma_f32 v96, v96, s64, -v92
    v_fma_f32 v97, v97, s64, -v92
    v_fma_f32 v98, v98, s64, -v92
    v_fma_f32 v99, v99, s64, -v92
    v_fma_f32 v100, v100, s64, -v92
    v_fma_f32 v101, v101, s64, -v92
    v_fma_f32 v102, v102, s64, -v92
    v_fma_f32 v103, v103, s64, -v92
    v_fma_f32 v104, v104, s64, -v92
    v_fma_f32 v105, v105, s64, -v92
    v_fma_f32 v106, v106, s64, -v92
    v_fma_f32 v107, v107, s64, -v92
    v_fma_f32 v108, v108, s64, -v92
    v_fma_f32 v109, v109, s64, -v92
    v_fma_f32 v110, v110, s64, -v92
    v_fma_f32 v111, v111, s64, -v92
    v_exp_f32 v96, v96
    v_exp_f32 v97, v97
    v_exp_f32 v98, v98
    v_exp_f32 v99, v99
    v_exp_f32 v100, v100
    v_exp_f32 v101, v101
    v_exp_f32 v102, v102
    v_exp_f32 v103, v103
    v_exp_f32 v104, v104
    v_exp_f32 v105, v105
    v_exp_f32 v106, v106
    v_exp_f32 v107, v107
    v_exp_f32 v108, v108
    v_exp_f32 v109, v109
    v_exp_f32 v110, v110
    v_exp_f32 v111, v111
    v_cvt_pk_bf16_f32 v144, v96, v97
    v_cvt_pk_bf16_f32 v145, v98, v99
    v_cvt_pk_bf16_f32 v146, v100, v101
    v_cvt_pk_bf16_f32 v147, v102, v103
    ds_write_b128 v74, v[144:147]
    v_cvt_pk_bf16_f32 v148, v104, v105
    v_cvt_pk_bf16_f32 v149, v106, v107
    v_cvt_pk_bf16_f32 v150, v108, v109
    v_cvt_pk_bf16_f32 v151, v110, v111
    ds_write_b128 v74, v[148:151] offset:1024
    v_pk_add_f32 v[96:97], v[96:97], v[104:105]
    v_pk_add_f32 v[98:99], v[98:99], v[106:107]
    v_pk_add_f32 v[100:101], v[100:101], v[108:109]
    v_pk_add_f32 v[102:103], v[102:103], v[110:111]
    v_pk_add_f32 v[96:97], v[96:97], v[100:101]
    v_pk_add_f32 v[98:99], v[98:99], v[102:103]
    v_pk_add_f32 v[96:97], v[96:97], v[98:99]
    v_add_f32 v64, v96, v97
    v_mov_b32 v63, v64
    s_nop 1
    v_permlane32_swap_b32 v64, v63
    v_add_f32 v64, v64, v63
    ds_write_b32 v72, v64 offset:512
    s_waitcnt lgkmcnt(0)
    s_barrier
    ds_read_b128 v[96:99], v75 offset:0
    ds_read_b128 v[100:103], v75 offset:1024
    ds_read_b128 v[104:107], v75 offset:2048
    ds_read_b128 v[108:111], v75 offset:3072
    ds_read_b128 v[112:115], v75 offset:4096
    ds_read_b128 v[116:119], v75 offset:5120
    ds_read_b128 v[120:123], v75 offset:6144
    ds_read_b128 v[124:127], v75 offset:7168
    ds_read_b128 v[68:71], v73 offset:512
    s_waitcnt lgkmcnt(8)
    v_mfma_f32_32x32x16_bf16 v[128:143], v[96:99], a[0:3], 0
    v_mfma_f32_32x32x16_bf16 v[144:159], v[96:99], a[4:7], 0
    v_mfma_f32_32x32x16_bf16 v[160:175], v[96:99], a[8:11], 0
    v_mfma_f32_32x32x16_bf16 v[176:191], v[96:99], a[12:15], 0
    s_waitcnt lgkmcnt(7)
    v_mfma_f32_32x32x16_bf16 v[128:143], v[100:103], a[16:19], v[128:143]
    v_mfma_f32_32x32x16_bf16 v[144:159], v[100:103], a[20:23], v[144:159]
    v_mfma_f32_32x32x16_bf16 v[160:175], v[100:103], a[24:27], v[160:175]
    v_mfma_f32_32x32x16_bf16 v[176:191], v[100:103], a[28:31], v[176:191]
    s_waitcnt lgkmcnt(0)
    v_add_f32 v93, v68, v69
    v_add_f32 v63, v70, v71
    v_add_f32 v93, v93, v63
    ds_bpermute_b32 v68, v76, v92
    ds_bpermute_b32 v69, v76, v93
    s_mov_b32 vcc_lo, 0xaaaaaaaa
    s_mov_b32 vcc_hi, 0xaaaaaaaa
    v_mfma_f32_32x32x16_bf16 v[128:143], v[104:107], a[32:35], v[128:143]
    v_mfma_f32_32x32x16_bf16 v[144:159], v[104:107], a[36:39], v[144:159]
    v_mfma_f32_32x32x16_bf16 v[160:175], v[104:107], a[40:43], v[160:175]
    v_mfma_f32_32x32x16_bf16 v[176:191], v[104:107], a[44:47], v[176:191]
    v_mfma_f32_32x32x16_bf16 v[128:143], v[108:111], a[48:51], v[128:143]
    v_mfma_f32_32x32x16_bf16 v[144:159], v[108:111], a[52:55], v[144:159]
    v_mfma_f32_32x32x16_bf16 v[160:175], v[108:111], a[56:59], v[160:175]
    v_mfma_f32_32x32x16_bf16 v[176:191], v[108:111], a[60:63], v[176:191]
    v_mfma_f32_32x32x16_bf16 v[128:143], v[112:115], a[64:67], v[128:143]
    v_mfma_f32_32x32x16_bf16 v[144:159], v[112:115], a[68:71], v[144:159]
    v_mfma_f32_32x32x16_bf16 v[160:175], v[112:115], a[72:75], v[160:175]
    v_mfma_f32_32x32x16_bf16 v[176:191], v[112:115], a[76:79], v[176:191]
    v_mfma_f32_32x32x16_bf16 v[128:143], v[116:119], a[80:83], v[128:143]
    v_mfma_f32_32x32x16_bf16 v[144:159], v[116:119], a[84:87], v[144:159]
    v_mfma_f32_32x32x16_bf16 v[160:175], v[116:119], a[88:91], v[160:175]
    v_mfma_f32_32x32x16_bf16 v[176:191], v[116:119], a[92:95], v[176:191]
    v_mfma_f32_32x32x16_bf16 v[128:143], v[120:123], a[96:99], v[128:143]
    v_mfma_f32_32x32x16_bf16 v[144:159], v[120:123], a[100:103], v[144:159]
    v_mfma_f32_32x32x16_bf16 v[160:175], v[120:123], a[104:107], v[160:175]
    v_mfma_f32_32x32x16_bf16 v[176:191], v[120:123], a[108:111], v[176:191]
    v_mfma_f32_32x32x16_bf16 v[128:143], v[124:127], a[112:115], v[128:143]
    v_mfma_f32_32x32x16_bf16 v[144:159], v[124:127], a[116:119], v[144:159]
    v_mfma_f32_32x32x16_bf16 v[160:175], v[124:127], a[120:123], v[160:175]
    v_mfma_f32_32x32x16_bf16 v[176:191], v[124:127], a[124:127], v[176:191]
    s_lshl1_add_u32 s56, s71, 1
    s_waitcnt lgkmcnt(0)
    v_add3_u32 v71, v68, v69, s56
    s_nop 6
    v_cvt_pk_bf16_f32 v96, v128, v144
    v_cvt_pk_bf16_f32 v98, v129, v145
    v_cvt_pk_bf16_f32 v97, v160, v176
    v_cvt_pk_bf16_f32 v99, v161, v177
    v_permlane16_swap_b32 v96, v98
    s_nop 0
    v_permlane16_swap_b32 v97, v99
    v_cvt_pk_bf16_f32 v100, v130, v146
    v_cvt_pk_bf16_f32 v102, v131, v147
    v_cvt_pk_bf16_f32 v101, v162, v178
    v_cvt_pk_bf16_f32 v103, v163, v179
    buffer_store_dwordx4 v[96:99], v80, s[24:27], s53 offen sc1
    v_permlane16_swap_b32 v100, v102
    v_permlane16_swap_b32 v101, v103
    v_cvt_pk_bf16_f32 v104, v132, v148
    v_cvt_pk_bf16_f32 v106, v133, v149
    v_cvt_pk_bf16_f32 v105, v164, v180
    v_cvt_pk_bf16_f32 v107, v165, v181
    buffer_store_dwordx4 v[100:103], v81, s[24:27], s53 offen sc1
    v_permlane16_swap_b32 v104, v106
    v_permlane16_swap_b32 v105, v107
    v_cvt_pk_bf16_f32 v108, v134, v150
    v_cvt_pk_bf16_f32 v110, v135, v151
    v_cvt_pk_bf16_f32 v109, v166, v182
    v_cvt_pk_bf16_f32 v111, v167, v183
    buffer_store_dwordx4 v[104:107], v82, s[24:27], s53 offen sc1
    v_permlane16_swap_b32 v108, v110
    v_permlane16_swap_b32 v109, v111
    v_cvt_pk_bf16_f32 v112, v136, v152
    v_cvt_pk_bf16_f32 v114, v137, v153
    v_cvt_pk_bf16_f32 v113, v168, v184
    v_cvt_pk_bf16_f32 v115, v169, v185
    buffer_store_dwordx4 v[108:111], v83, s[24:27], s53 offen sc1
    v_permlane16_swap_b32 v112, v114
    v_permlane16_swap_b32 v113, v115
    v_cvt_pk_bf16_f32 v116, v138, v154
    v_cvt_pk_bf16_f32 v118, v139, v155
    v_cvt_pk_bf16_f32 v117, v170, v186
    v_cvt_pk_bf16_f32 v119, v171, v187
    buffer_store_dwordx4 v[112:115], v84, s[24:27], s53 offen sc1
    v_permlane16_swap_b32 v116, v118
    v_permlane16_swap_b32 v117, v119
    v_cvt_pk_bf16_f32 v120, v140, v156
    v_cvt_pk_bf16_f32 v122, v141, v157
    v_cvt_pk_bf16_f32 v121, v172, v188
    v_cvt_pk_bf16_f32 v123, v173, v189
    buffer_store_dwordx4 v[116:119], v85, s[24:27], s53 offen sc1
    v_permlane16_swap_b32 v120, v122
    v_permlane16_swap_b32 v121, v123
    v_cvt_pk_bf16_f32 v124, v142, v158
    v_cvt_pk_bf16_f32 v126, v143, v159
    v_cvt_pk_bf16_f32 v125, v174, v190
    v_cvt_pk_bf16_f32 v127, v175, v191
    buffer_store_dwordx4 v[120:123], v86, s[24:27], s53 offen sc1
    v_permlane16_swap_b32 v124, v126
    v_permlane16_swap_b32 v125, v127
    buffer_store_dwordx4 v[124:127], v87, s[24:27], s53 offen sc1
    v_add3_u32 v192, v96, v97, v98
    v_add_u32 v192, v99, v192
    v_add3_u32 v193, v100, v101, v102
    v_add_u32 v193, v103, v193
    v_add3_u32 v194, v104, v105, v106
    v_add_u32 v194, v107, v194
    v_add3_u32 v195, v108, v109, v110
    v_add_u32 v195, v111, v195
    v_add3_u32 v196, v112, v113, v114
    v_add_u32 v196, v115, v196
    v_add3_u32 v197, v116, v117, v118
    v_add_u32 v197, v119, v197
    v_add3_u32 v198, v120, v121, v122
    v_add_u32 v198, v123, v198
    v_add3_u32 v199, v124, v125, v126
    v_add_u32 v199, v127, v199
    v_add_u32_dpp v192, v192, v192 quad_perm:[1,0,3,2] row_mask:0xf bank_mask:0xf
    v_add_u32_dpp v193, v193, v193 quad_perm:[1,0,3,2] row_mask:0xf bank_mask:0xf
    v_add_u32_dpp v194, v194, v194 quad_perm:[1,0,3,2] row_mask:0xf bank_mask:0xf
    v_add_u32_dpp v195, v195, v195 quad_perm:[1,0,3,2] row_mask:0xf bank_mask:0xf
    v_add_u32_dpp v196, v196, v196 quad_perm:[1,0,3,2] row_mask:0xf bank_mask:0xf
    v_add_u32_dpp v197, v197, v197 quad_perm:[1,0,3,2] row_mask:0xf bank_mask:0xf
    v_add_u32_dpp v198, v198, v198 quad_perm:[1,0,3,2] row_mask:0xf bank_mask:0xf
    v_add_u32_dpp v199, v199, v199 quad_perm:[1,0,3,2] row_mask:0xf bank_mask:0xf
    v_add_u32_dpp v192, v192, v192 quad_perm:[2,3,0,1] row_mask:0xf bank_mask:0xf
    v_add_u32_dpp v193, v193, v193 quad_perm:[2,3,0,1] row_mask:0xf bank_mask:0xf
    v_add_u32_dpp v194, v194, v194 quad_perm:[2,3,0,1] row_mask:0xf bank_mask:0xf
    v_add_u32_dpp v195, v195, v195 quad_perm:[2,3,0,1] row_mask:0xf bank_mask:0xf
    v_add_u32_dpp v196, v196, v196 quad_perm:[2,3,0,1] row_mask:0xf bank_mask:0xf
    v_add_u32_dpp v197, v197, v197 quad_perm:[2,3,0,1] row_mask:0xf bank_mask:0xf
    v_add_u32_dpp v198, v198, v198 quad_perm:[2,3,0,1] row_mask:0xf bank_mask:0xf
    v_add_u32_dpp v199, v199, v199 quad_perm:[2,3,0,1] row_mask:0xf bank_mask:0xf
    v_add_u32_dpp v192, v192, v192 row_half_mirror row_mask:0xf bank_mask:0xf
    v_add_u32_dpp v193, v193, v193 row_half_mirror row_mask:0xf bank_mask:0xf
    v_add_u32_dpp v194, v194, v194 row_half_mirror row_mask:0xf bank_mask:0xf
    v_add_u32_dpp v195, v195, v195 row_half_mirror row_mask:0xf bank_mask:0xf
    v_add_u32_dpp v196, v196, v196 row_half_mirror row_mask:0xf bank_mask:0xf
    v_add_u32_dpp v197, v197, v197 row_half_mirror row_mask:0xf bank_mask:0xf
    v_add_u32_dpp v198, v198, v198 row_half_mirror row_mask:0xf bank_mask:0xf
    v_add_u32_dpp v199, v199, v199 row_half_mirror row_mask:0xf bank_mask:0xf
    v_add_u32_dpp v200, v192, v192 row_mirror row_mask:0xf bank_mask:0x1
    v_add_u32_dpp v201, v196, v196 row_mirror row_mask:0xf bank_mask:0x1
    s_nop 0
    v_add_u32_dpp v200, v193, v193 row_mirror row_mask:0xf bank_mask:0x2
    v_add_u32_dpp v201, v197, v197 row_mirror row_mask:0xf bank_mask:0x2
    s_nop 0
    v_add_u32_dpp v200, v194, v194 row_mirror row_mask:0xf bank_mask:0x4
    v_add_u32_dpp v201, v198, v198 row_mirror row_mask:0xf bank_mask:0x4
    s_nop 0
    v_add_u32_dpp v200, v195, v195 row_mirror row_mask:0xf bank_mask:0x8
    v_add_u32_dpp v201, v199, v199 row_mirror row_mask:0xf bank_mask:0x8
    v_cndmask_b32 v200, v200, v201, vcc
    v_add_u32 v70, s71, v200
    v_add_u32 v71, v71, v70
    buffer_store_dwordx4 v[68:71], v88, s[24:27], s52 offen sc1
    s_waitcnt vmcnt(1)
    s_waitcnt vmcnt(0)
    s_add_u32 m0, s59, 32768
    s_waitcnt vmcnt(31)
    buffer_load_dwordx4 v28, s[12:15], s16 offen nt lds
    s_add_u32 s16, s16, 4608
    s_mul_i32 s16, s3, 9216
    s_add_u32 s16, s16, s19
    s_add_u32 s16, s16, 1024
    s_add_u32 m0, s59, 36864
    s_nop 0
    buffer_load_dwordx4 v30, s[12:15], s16 offen nt lds
    s_add_u32 s16, s19, 37888
    s_mov_b64 exec, 0xffffffff
    s_mov_b32 m0, 40960
    s_nop 0
    buffer_load_dwordx4 v30, s[12:15], s16 offen nt lds
    s_mov_b64 exec, -1
    v_lshlrev_b32 v58, 4, v0
    s_mul_i32 s52, s70, 6912
    s_add_u32 s52, s52, 1114112
    s_add_u32 s53, s52, 4096
    s_movk_i32 s63, 176
    v_cmp_gt_u32 s[54:55], s63, v0
    v_mov_b32 v52, v3
    v_mov_b32 v53, v3
    v_mov_b32 v54, v3
    v_mov_b32 v55, v3
    buffer_load_dwordx4 v[48:51], v58, s[24:27], s52 offen sc1
    s_mov_b64 exec, s[54:55]
    buffer_load_dwordx4 v[52:55], v58, s[24:27], s53 offen sc1
    s_mov_b64 exec, -1
    s_add_u32 m0, s59, 51200
    s_waitcnt vmcnt(31)
    buffer_load_dwordx4 v26, s[20:23], s17 offen nt lds
    s_add_u32 s17, s17, 18432
    s_add_u32 m0, s59, 55296
    s_waitcnt vmcnt(31)
    buffer_load_dwordx4 v26, s[20:23], s17 offen nt lds
    s_add_u32 s17, s17, 18432
    s_add_u32 m0, s59, 59392
    s_waitcnt vmcnt(31)
    buffer_load_dwordx4 v26, s[20:23], s17 offen nt lds
    s_add_u32 s17, s17, 18432
    s_add_u32 m0, s59, 63488
    s_waitcnt vmcnt(31)
    buffer_load_dwordx4 v26, s[20:23], s17 offen nt lds
    s_add_u32 s17, s17, 18432
    s_add_u32 m0, s59, 67584
    s_waitcnt vmcnt(31)
    buffer_load_dwordx4 v26, s[20:23], s17 offen nt lds
    s_add_u32 s17, s17, 18432
    s_add_u32 m0, s59, 71680
    s_waitcnt vmcnt(31)
    buffer_load_dwordx4 v26, s[20:23], s17 offen nt lds
    s_add_u32 s17, s17, 18432
    s_add_u32 m0, s59, 75776
    s_waitcnt vmcnt(31)
    buffer_load_dwordx4 v26, s[20:23], s17 offen nt lds
    s_add_u32 s17, s17, 18432
    s_add_u32 m0, s59, 79872
    s_waitcnt vmcnt(31)
    buffer_load_dwordx4 v26, s[20:23], s17 offen nt lds
    s_add_u32 s17, s17, 18432
    s_add_u32 m0, s59, 83968
    s_nop 0
    buffer_load_dwordx4 v27, s[20:23], s18 offen nt lds
    s_add_u32 s18, s18, 36864
    s_add_u32 m0, s59, 88064
    s_nop 0
    buffer_load_dwordx4 v27, s[20:23], s18 offen nt lds
    s_add_u32 s18, s18, 36864
    s_add_u32 m0, s59, 92160
    s_nop 0
    buffer_load_dwordx4 v27, s[20:23], s18 offen nt lds
    s_add_u32 s18, s18, 36864
    s_add_u32 m0, s59, 96256
    s_nop 0
    buffer_load_dwordx4 v27, s[20:23], s18 offen nt lds
    s_add_u32 s18, s18, 36864
    s_waitcnt vmcnt(26)
    v_add_u32 v170, s59, v2
    v_add_u32 v171, 51200, v170
    ds_write_b128 v170, a[128:131] offset:0
    ds_write_b128 v170, a[132:135] offset:4096
    ds_write_b128 v170, a[136:139] offset:8192
    ds_write_b128 v170, a[140:143] offset:12288
    ds_write_b128 v170, a[144:147] offset:16384
    ds_write_b128 v170, a[148:151] offset:20480
    ds_write_b128 v170, a[152:155] offset:24576
    ds_write_b128 v170, a[156:159] offset:28672
    v_lshl_add_u32 v179, v16, 2, v17
    v_and_b32 v180, 1, v18
    v_lshlrev_b32 v180, 3, v180
    v_lshlrev_b32 v181, 6, v16
    v_lshl_add_u32 v181, v18, 4, v181
    v_lshl_add_u32 v182, v17, 11, v181
    s_lshl_b32 s63, s3, 8
    v_add_u32 v183, s63, v181
    v_and_b32 v4, 7, v179
    v_lshlrev_b32 v4, 1, v4
    s_lshl_b32 s63, s3, 1
    v_lshrrev_b32 v5, 1, v18
    v_add_u32 v5, s63, v5
    v_xor_b32 v4, v4, v5
    v_lshl_add_u32 v4, v4, 4, v180
    v_lshl_add_u32 v170, v179, 10, v4
    v_xor_b32 v171, 128, v170
    v_lshl_add_u32 v176, v179, 8, v4
    v_add_u32 v176, 51200, v176
    v_xor_b32 v177, 128, v176
    v_lshlrev_b32 v4, 1, v17
    v_xor_b32 v4, v4, v5
    v_lshl_add_u32 v4, v4, 4, v180
    v_lshl_add_u32 v172, v17, 10, v4
    v_xor_b32 v173, 128, v172
    v_and_b32 v4, 6, v179
    v_xor_b32 v4, v4, v5
    v_lshl_add_u32 v4, v4, 4, v180
    v_lshl_add_u32 v174, v179, 7, v4
    v_and_b32 v4, 2, v17
    v_xor_b32 v4, v4, v5
    v_lshl_add_u32 v4, v4, 4, v180
    v_lshl_add_u32 v175, v17, 7, v4
    s_lshl_b32 s63, s3, 5
    s_add_u32 s63, s63, 83968
    v_lshlrev_b32 v178, 7, v179
    v_lshl_add_u32 v178, v18, 3, v178
    v_add_u32 v178, s63, v178
    v_lshl_add_u32 v4, v17, 2, v16
    v_min_u32 v4, 8, v4
    v_mul_u32_u24 v59, 768, v4
    v_lshl_add_u32 v59, v18, 4, v59
    v_lshrrev_b32 v4, 5, v1
    v_mul_u32_u24 v168, 16512, v4
    v_and_b32 v4, 1, v16
    v_lshl_add_u32 v168, v4, 6, v168
    v_lshl_add_u32 v168, v18, 4, v168
    v_lshl_add_u32 v168, v17, 28, v168
    s_lshl_b32 s66, s70, 7
    s_mul_i32 s64, s3, 33024
    s_add_u32 s66, s66, s64
    s_add_u32 s66, s66, 2097152
    s_lshl_b32 s56, s57, 13
    s_lshl_b32 s64, s3, 9
    s_add_u32 s56, s56, s64
    s_add_u32 s56, s56, 802816
    s_waitcnt vmcnt(12)
    v_bitop3_b32 v56, v48, v49, v50 bitop3:0x7e
    v_bitop3_b32 v57, v48, v51, v3 bitop3:0x7e
    v_bitop3_b32 v56, v56, v57, s67 bitop3:0xa8
    v_cmp_ne_u32 s[36:37], 0, v56
    v_bitop3_b32 v56, v52, v53, v54 bitop3:0x7e
    v_bitop3_b32 v57, v52, v55, v3 bitop3:0x7e
    v_bitop3_b32 v56, v56, v57, s67 bitop3:0xa8
    v_cmp_ne_u32 s[38:39], 0, v56
    s_nop 0
    s_or_b64 s[40:41], s[36:37], s[38:39]
    s_mov_b32 s69, 40000
    s_cmp_eq_u64 s[40:41], 0
    s_cbranch_scc1 Lpd_12
Lp_11:
    s_mov_b64 exec, s[36:37]
    buffer_load_dwordx4 v[48:51], v58, s[24:27], s52 offen sc1
    s_mov_b64 exec, s[38:39]
    buffer_load_dwordx4 v[52:55], v58, s[24:27], s53 offen sc1
    s_mov_b64 exec, -1
Lpc_13:
    s_waitcnt vmcnt(0)
    v_bitop3_b32 v56, v48, v49, v50 bitop3:0x7e
    v_bitop3_b32 v57, v48, v51, v3 bitop3:0x7e
    v_bitop3_b32 v56, v56, v57, s67 bitop3:0xa8
    v_cmp_ne_u32 s[36:37], 0, v56
    v_bitop3_b32 v56, v52, v53, v54 bitop3:0x7e
    v_bitop3_b32 v57, v52, v55, v3 bitop3:0x7e
    v_bitop3_b32 v56, v56, v57, s67 bitop3:0xa8
    v_cmp_ne_u32 s[38:39], 0, v56
    s_nop 0
    s_or_b64 vcc, s[36:37], s[38:39]
    s_nop 1
    s_cbranch_scc0 Lpd_12
    s_sub_u32 s69, s69, 1
    s_cbranch_scc0 Lp_11
Lpd_12:
    v_xor_b32 v48, v3, v48
    v_xor_b32 v49, v3, v49
    v_xor_b32 v50, v3, v50
    v_xor_b32 v51, v3, v51
    v_xor_b32 v52, v3, v52
    v_xor_b32 v53, v3, v53
    v_xor_b32 v54, v3, v54
    v_xor_b32 v55, v3, v55
    ds_write_b128 v58, v[48:51] offset:41984
    ds_write_b128 v58, v[52:55] offset:46080
    s_waitcnt lgkmcnt(0)
    s_barrier
    ds_read_b128 v[104:107], v59 offset:41984
    ds_read_b128 v[108:111], v59 offset:42048
    ds_read_b128 v[112:115], v59 offset:42112
    ds_read_b128 v[116:119], v59 offset:42176
    ds_read_b128 v[120:123], v59 offset:42240
    ds_read_b128 v[124:127], v59 offset:42304
    ds_read_b128 v[128:131], v59 offset:42368
    ds_read_b128 v[132:135], v59 offset:42432
    ds_read_b128 v[136:139], v59 offset:42496
    ds_read_b128 v[140:143], v59 offset:42560
    ds_read_b128 v[144:147], v59 offset:42624
    ds_read_b128 v[148:151], v59 offset:42688
    s_waitcnt lgkmcnt(6)
    v_pk_add_f32 v[104:105], v[104:105], v[116:117]
    v_pk_add_f32 v[106:107], v[106:107], v[118:119]
    v_pk_add_f32 v[108:109], v[108:109], v[120:121]
    v_pk_add_f32 v[110:111], v[110:111], v[122:123]
    v_pk_add_f32 v[112:113], v[112:113], v[124:125]
    v_pk_add_f32 v[114:115], v[114:115], v[126:127]
    v_pk_add_f32 v[104:105], v[104:105], v[108:109]
    v_pk_add_f32 v[106:107], v[106:107], v[110:111]
    v_pk_add_f32 v[104:105], v[104:105], v[112:113]
    v_pk_add_f32 v[106:107], v[106:107], v[114:115]
    v_mul_f32 v108, -1.4426950408889634, v104
    v_mul_f32 v109, -1.4426950408889634, v105
    v_mul_f32 v110, -1.4426950408889634, v106
    v_mul_f32 v111, -1.4426950408889634, v107
    v_exp_f32 v108, v108
    v_exp_f32 v109, v109
    v_exp_f32 v110, v110
    v_exp_f32 v111, v111
    s_waitcnt lgkmcnt(0)
    ds_read_b64_tr_b16 a[48:49], v170 offset:0
    ds_read_b64_tr_b16 a[50:51], v170 offset:16384
    ds_read_b64_tr_b16 a[52:53], v172 offset:32768
    ds_read_b64_tr_b16 a[54:55], v171 offset:0
    ds_read_b64_tr_b16 a[56:57], v171 offset:16384
    ds_read_b64_tr_b16 a[58:59], v173 offset:32768
    ds_read_b64_tr_b16 a[60:61], v170 offset:256
    ds_read_b64_tr_b16 a[62:63], v170 offset:16640
    ds_read_b64_tr_b16 a[64:65], v172 offset:33024
    ds_read_b64_tr_b16 a[66:67], v171 offset:256
    ds_read_b64_tr_b16 a[68:69], v171 offset:16640
    ds_read_b64_tr_b16 a[70:71], v173 offset:33024
    ds_read_b64_tr_b16 a[72:73], v170 offset:512
    ds_read_b64_tr_b16 a[74:75], v170 offset:16896
    ds_read_b64_tr_b16 a[76:77], v172 offset:33280
    ds_read_b64_tr_b16 a[78:79], v171 offset:512
    ds_read_b64_tr_b16 a[80:81], v171 offset:16896
    ds_read_b64_tr_b16 a[82:83], v173 offset:33280
    ds_read_b64_tr_b16 a[84:85], v170 offset:768
    ds_read_b64_tr_b16 a[86:87], v170 offset:17152
    ds_read_b64_tr_b16 a[88:89], v172 offset:33536
    ds_read_b64_tr_b16 a[90:91], v171 offset:768
    ds_read_b64_tr_b16 a[92:93], v171 offset:17152
    ds_read_b64_tr_b16 a[94:95], v173 offset:33536
    ds_read_b64_tr_b16 a[96:97], v174 offset:36864
    ds_read_b64_tr_b16 a[98:99], v174 offset:38912
    ds_read_b64_tr_b16 a[100:101], v175 offset:40960
    v_pk_add_f32 v[128:129], v[128:129], v[140:141]
    v_pk_add_f32 v[130:131], v[130:131], v[142:143]
    v_pk_add_f32 v[132:133], v[132:133], v[144:145]
    v_pk_add_f32 v[134:135], v[134:135], v[146:147]
    v_pk_add_f32 v[136:137], v[136:137], v[148:149]
    v_pk_add_f32 v[138:139], v[138:139], v[150:151]
    v_pk_add_f32 v[128:129], v[128:129], v[132:133]
    v_pk_add_f32 v[130:131], v[130:131], v[134:135]
    v_pk_add_f32 v[128:129], v[128:129], v[136:137]
    v_pk_add_f32 v[130:131], v[130:131], v[138:139]
    v_add_f32 v108, 1.0, v108
    v_add_f32 v109, 1.0, v109
    v_add_f32 v110, 1.0, v110
    v_add_f32 v111, 1.0, v111
    v_rcp_f32 v108, v108
    v_rcp_f32 v109, v109
    v_rcp_f32 v110, v110
    v_rcp_f32 v111, v111
    v_pk_mul_f32 v[104:105], v[104:105], v[128:129]
    v_pk_mul_f32 v[106:107], v[106:107], v[130:131]
    v_pk_mul_f32 v[104:105], v[104:105], v[108:109]
    v_pk_mul_f32 v[106:107], v[106:107], v[110:111]
    v_cvt_pk_bf16_f32 v60, v104, v105
    v_cvt_pk_bf16_f32 v61, v106, v107
    v_mov_b32 v64, 0
    v_mov_b32 v65, 0
    v_mov_b32_dpp v62, v60 row_shl:4 row_mask:0xf bank_mask:0xf bound_ctrl:0
    v_mov_b32_dpp v63, v61 row_shl:4 row_mask:0xf bank_mask:0xf bound_ctrl:0
    v_mov_b32_dpp v64, v60 row_shl:8 row_mask:0x1 bank_mask:0xf bound_ctrl:0
    v_mov_b32_dpp v65, v61 row_shl:8 row_mask:0x1 bank_mask:0xf bound_ctrl:0
    s_waitcnt lgkmcnt(15)
    v_mfma_f32_16x16x32_bf16 v[68:71], a[48:51], v[60:63], 0
    s_waitcnt lgkmcnt(15)
    v_mfma_f32_16x16x32_bf16 v[72:75], a[54:57], v[60:63], 0
    s_waitcnt lgkmcnt(15)
    v_mfma_f32_16x16x32_bf16 v[76:79], a[60:63], v[60:63], 0
    s_waitcnt lgkmcnt(15)
    v_mfma_f32_16x16x32_bf16 v[80:83], a[66:69], v[60:63], 0
    s_waitcnt lgkmcnt(12)
    v_mfma_f32_16x16x32_bf16 v[84:87], a[72:75], v[60:63], 0
    s_waitcnt lgkmcnt(9)
    v_mfma_f32_16x16x32_bf16 v[88:91], a[78:81], v[60:63], 0
    s_waitcnt lgkmcnt(6)
    v_mfma_f32_16x16x32_bf16 v[92:95], a[84:87], v[60:63], 0
    s_waitcnt lgkmcnt(3)
    v_mfma_f32_16x16x32_bf16 v[96:99], a[90:93], v[60:63], 0
    s_waitcnt lgkmcnt(0)
    v_mfma_f32_16x16x32_bf16 v[100:103], a[96:99], v[60:63], 0
    v_mfma_f32_16x16x16_bf16 v[68:71], a[52:53], v[64:65], v[68:71]
    v_mfma_f32_16x16x16_bf16 v[72:75], a[58:59], v[64:65], v[72:75]
    v_mfma_f32_16x16x16_bf16 v[76:79], a[64:65], v[64:65], v[76:79]
    v_mfma_f32_16x16x16_bf16 v[80:83], a[70:71], v[64:65], v[80:83]
    v_mfma_f32_16x16x16_bf16 v[84:87], a[76:77], v[64:65], v[84:87]
    v_mfma_f32_16x16x16_bf16 v[88:91], a[82:83], v[64:65], v[88:91]
    v_mfma_f32_16x16x16_bf16 v[92:95], a[88:89], v[64:65], v[92:95]
    v_mfma_f32_16x16x16_bf16 v[96:99], a[94:95], v[64:65], v[96:99]
    v_mfma_f32_16x16x16_bf16 v[100:103], a[100:101], v[64:65], v[100:103]
    buffer_load_dwordx4 v[32:35], v182, s[24:27], s56 offen offset:0 sc1
    buffer_load_dwordx4 v[36:39], v182, s[24:27], s56 offen offset:256 sc1
    s_mov_b32 s69, 40000
    s_waitcnt vmcnt(2)
    s_barrier
    ds_read_b64_tr_b16 a[0:1], v176 offset:0
    ds_read_b64_tr_b16 a[2:3], v176 offset:4096
    ds_read_b64_tr_b16 a[4:5], v176 offset:8192
    ds_read_b64_tr_b16 a[6:7], v176 offset:12288
    ds_read_b64_tr_b16 a[8:9], v176 offset:16384
    ds_read_b64_tr_b16 a[10:11], v176 offset:20480
    ds_read_b64_tr_b16 a[12:13], v176 offset:24576
    ds_read_b64_tr_b16 a[14:15], v176 offset:28672
    ds_read_b64_tr_b16 a[16:17], v177 offset:0
    ds_read_b64_tr_b16 a[18:19], v177 offset:4096
    ds_read_b64_tr_b16 a[20:21], v177 offset:8192
    ds_read_b64_tr_b16 a[22:23], v177 offset:12288
    ds_read_b64_tr_b16 a[24:25], v177 offset:16384
    ds_read_b64_tr_b16 a[26:27], v177 offset:20480
    ds_read_b64_tr_b16 a[28:29], v177 offset:24576
    ds_read_b64_tr_b16 a[30:31], v177 offset:28672
    ds_read_b64_tr_b16 a[32:33], v178 offset:0
    ds_read_b64_tr_b16 a[34:35], v178 offset:2048
    ds_read_b64_tr_b16 a[36:37], v178 offset:4096
    ds_read_b64_tr_b16 a[38:39], v178 offset:6144
    ds_read_b64_tr_b16 a[40:41], v178 offset:8192
    ds_read_b64_tr_b16 a[42:43], v178 offset:10240
    ds_read_b64_tr_b16 a[44:45], v178 offset:12288
    ds_read_b64_tr_b16 a[46:47], v178 offset:14336
Lq_14:
    s_waitcnt vmcnt(0)
    v_bitop3_b32 v56, v32, v33, v34 bitop3:0x7e
    v_bitop3_b32 v57, v32, v35, v3 bitop3:0x7e
    v_bitop3_b32 v56, v56, v57, s67 bitop3:0xa8
    v_cmp_ne_u32 s[36:37], 0, v56
    v_bitop3_b32 v56, v36, v37, v38 bitop3:0x7e
    v_bitop3_b32 v57, v36, v39, v3 bitop3:0x7e
    v_bitop3_b32 v56, v56, v57, s67 bitop3:0xa8
    v_cmp_ne_u32 s[38:39], 0, v56
    s_nop 0
    s_or_b64 vcc, s[36:37], s[38:39]
    s_nop 1
    s_cbranch_scc0 Lqd_15
    s_mov_b64 exec, s[36:37]
    buffer_load_dwordx4 v[32:35], v182, s[24:27], s56 offen offset:0 sc1
    s_mov_b64 exec, s[38:39]
    buffer_load_dwordx4 v[36:39], v182, s[24:27], s56 offen offset:256 sc1
    s_mov_b64 exec, -1
    s_sub_u32 s69, s69, 1
    s_cbranch_scc0 Lq_14
Lqd_15:
    v_xor_b32 v32, v3, v32
    v_xor_b32 v33, v3, v33
    v_xor_b32 v34, v3, v34
    v_xor_b32 v35, v3, v35
    v_xor_b32 v36, v3, v36
    v_xor_b32 v37, v3, v37
    v_xor_b32 v38, v3, v38
    v_xor_b32 v39, v3, v39
    v_add_f32_dpp v40, v32, v32 row_ror:4 row_mask:0xf bank_mask:0xf
    v_add_f32_dpp v41, v33, v33 row_ror:4 row_mask:0xf bank_mask:0xf
    v_add_f32_dpp v42, v34, v34 row_ror:4 row_mask:0xf bank_mask:0xf
    v_add_f32_dpp v43, v35, v35 row_ror:4 row_mask:0xf bank_mask:0xf
    v_add_f32_dpp v44, v36, v36 row_ror:4 row_mask:0xf bank_mask:0xf
    v_add_f32_dpp v45, v37, v37 row_ror:4 row_mask:0xf bank_mask:0xf
    v_add_f32_dpp v46, v38, v38 row_ror:4 row_mask:0xf bank_mask:0xf
    v_add_f32_dpp v47, v39, v39 row_ror:4 row_mask:0xf bank_mask:0xf
    v_add_f32_dpp v40, v40, v40 row_ror:8 row_mask:0xf bank_mask:0xf
    v_add_f32_dpp v41, v41, v41 row_ror:8 row_mask:0xf bank_mask:0xf
    v_add_f32_dpp v42, v42, v42 row_ror:8 row_mask:0xf bank_mask:0xf
    v_add_f32_dpp v43, v43, v43 row_ror:8 row_mask:0xf bank_mask:0xf
    v_add_f32_dpp v44, v44, v44 row_ror:8 row_mask:0xf bank_mask:0xf
    v_add_f32_dpp v45, v45, v45 row_ror:8 row_mask:0xf bank_mask:0xf
    v_add_f32_dpp v46, v46, v46 row_ror:8 row_mask:0xf bank_mask:0xf
    v_add_f32_dpp v47, v47, v47 row_ror:8 row_mask:0xf bank_mask:0xf
    v_cvt_pk_bf16_f32 v40, v40, v41
    v_cvt_pk_bf16_f32 v41, v42, v43
    v_cvt_pk_bf16_f32 v42, v44, v45
    v_cvt_pk_bf16_f32 v43, v46, v47
    ds_write_b128 v183, v[40:43] offset:50176
    s_waitcnt lgkmcnt(0)
    s_barrier
    ds_read_b128 v[152:155], v181 offset:50176
    ds_read_b128 v[156:159], v181 offset:50432
    ds_read_b128 v[160:163], v181 offset:50688
    ds_read_b128 v[164:167], v181 offset:50944
    s_cmp_lg_u32 s58, 0
    s_cbranch_scc1 L_wo1
    v_and_or_b32 v76, v76, s68, v3
    v_and_or_b32 v77, v77, s68, v3
    v_and_or_b32 v78, v78, s68, v3
    v_and_or_b32 v79, v79, s68, v3
    s_add_u32 s63, s66, 264192
    buffer_store_dwordx4 v[76:79], v168, s[24:27], s63 offen sc1
    v_and_or_b32 v80, v80, s68, v3
    v_and_or_b32 v81, v81, s68, v3
    v_and_or_b32 v82, v82, s68, v3
    v_and_or_b32 v83, v83, s68, v3
    s_add_u32 s63, s66, 396288
    buffer_store_dwordx4 v[80:83], v168, s[24:27], s63 offen sc1
    s_waitcnt lgkmcnt(3)
    v_mfma_f32_16x16x32_bf16 v[68:71], a[0:3], v[152:155], v[68:71]
    v_mfma_f32_16x16x32_bf16 v[72:75], a[16:19], v[152:155], v[72:75]
    s_waitcnt lgkmcnt(2)
    v_mfma_f32_16x16x32_bf16 v[68:71], a[4:7], v[156:159], v[68:71]
    v_mfma_f32_16x16x32_bf16 v[72:75], a[20:23], v[156:159], v[72:75]
    s_waitcnt lgkmcnt(1)
    v_mfma_f32_16x16x32_bf16 v[68:71], a[8:11], v[160:163], v[68:71]
    v_mfma_f32_16x16x32_bf16 v[72:75], a[24:27], v[160:163], v[72:75]
    s_waitcnt lgkmcnt(0)
    v_mfma_f32_16x16x32_bf16 v[68:71], a[12:15], v[164:167], v[68:71]
    v_mfma_f32_16x16x32_bf16 v[72:75], a[28:31], v[164:167], v[72:75]
    v_and_or_b32 v84, v84, s68, v3
    v_and_or_b32 v85, v85, s68, v3
    v_and_or_b32 v86, v86, s68, v3
    v_and_or_b32 v87, v87, s68, v3
    s_add_u32 s63, s66, 528384
    buffer_store_dwordx4 v[84:87], v168, s[24:27], s63 offen sc1
    v_and_or_b32 v88, v88, s68, v3
    v_and_or_b32 v89, v89, s68, v3
    v_and_or_b32 v90, v90, s68, v3
    v_and_or_b32 v91, v91, s68, v3
    s_add_u32 s63, s66, 660480
    buffer_store_dwordx4 v[88:91], v168, s[24:27], s63 offen sc1
    v_and_or_b32 v68, v68, s68, v3
    v_and_or_b32 v69, v69, s68, v3
    v_and_or_b32 v70, v70, s68, v3
    v_and_or_b32 v71, v71, s68, v3
    s_add_u32 s63, s66, 0
    buffer_store_dwordx4 v[68:71], v168, s[24:27], s63 offen sc1
    v_and_or_b32 v72, v72, s68, v3
    v_and_or_b32 v73, v73, s68, v3
    v_and_or_b32 v74, v74, s68, v3
    v_and_or_b32 v75, v75, s68, v3
    s_add_u32 s63, s66, 132096
    buffer_store_dwordx4 v[72:75], v168, s[24:27], s63 offen sc1
    v_and_or_b32 v92, v92, s68, v3
    v_and_or_b32 v93, v93, s68, v3
    v_and_or_b32 v94, v94, s68, v3
    v_and_or_b32 v95, v95, s68, v3
    s_add_u32 s63, s66, 792576
    buffer_store_dwordx4 v[92:95], v168, s[24:27], s63 offen sc1
    v_and_or_b32 v96, v96, s68, v3
    v_and_or_b32 v97, v97, s68, v3
    v_and_or_b32 v98, v98, s68, v3
    v_and_or_b32 v99, v99, s68, v3
    s_add_u32 s63, s66, 924672
    buffer_store_dwordx4 v[96:99], v168, s[24:27], s63 offen sc1
    v_and_or_b32 v100, v100, s68, v3
    v_and_or_b32 v101, v101, s68, v3
    v_and_or_b32 v102, v102, s68, v3
    v_and_or_b32 v103, v103, s68, v3
    s_add_u32 s63, s66, 1056768
    buffer_store_dwordx4 v[100:103], v168, s[24:27], s63 offen sc1
    s_nop 0
    s_branch L_fin
L_wo1:
    s_cmp_lg_u32 s58, 1
    s_cbranch_scc1 L_wo2
    v_and_or_b32 v68, v68, s68, v3
    v_and_or_b32 v69, v69, s68, v3
    v_and_or_b32 v70, v70, s68, v3
    v_and_or_b32 v71, v71, s68, v3
    s_add_u32 s63, s66, 0
    buffer_store_dwordx4 v[68:71], v168, s[24:27], s63 offen sc1
    v_and_or_b32 v72, v72, s68, v3
    v_and_or_b32 v73, v73, s68, v3
    v_and_or_b32 v74, v74, s68, v3
    v_and_or_b32 v75, v75, s68, v3
    s_add_u32 s63, s66, 132096
    buffer_store_dwordx4 v[72:75], v168, s[24:27], s63 offen sc1
    s_waitcnt lgkmcnt(3)
    v_mfma_f32_16x16x32_bf16 v[76:79], a[0:3], v[152:155], v[76:79]
    v_mfma_f32_16x16x32_bf16 v[80:83], a[16:19], v[152:155], v[80:83]
    s_waitcnt lgkmcnt(2)
    v_mfma_f32_16x16x32_bf16 v[76:79], a[4:7], v[156:159], v[76:79]
    v_mfma_f32_16x16x32_bf16 v[80:83], a[20:23], v[156:159], v[80:83]
    s_waitcnt lgkmcnt(1)
    v_mfma_f32_16x16x32_bf16 v[76:79], a[8:11], v[160:163], v[76:79]
    v_mfma_f32_16x16x32_bf16 v[80:83], a[24:27], v[160:163], v[80:83]
    s_waitcnt lgkmcnt(0)
    v_mfma_f32_16x16x32_bf16 v[76:79], a[12:15], v[164:167], v[76:79]
    v_mfma_f32_16x16x32_bf16 v[80:83], a[28:31], v[164:167], v[80:83]
    v_and_or_b32 v84, v84, s68, v3
    v_and_or_b32 v85, v85, s68, v3
    v_and_or_b32 v86, v86, s68, v3
    v_and_or_b32 v87, v87, s68, v3
    s_add_u32 s63, s66, 528384
    buffer_store_dwordx4 v[84:87], v168, s[24:27], s63 offen sc1
    v_and_or_b32 v88, v88, s68, v3
    v_and_or_b32 v89, v89, s68, v3
    v_and_or_b32 v90, v90, s68, v3
    v_and_or_b32 v91, v91, s68, v3
    s_add_u32 s63, s66, 660480
    buffer_store_dwordx4 v[88:91], v168, s[24:27], s63 offen sc1
    v_and_or_b32 v76, v76, s68, v3
    v_and_or_b32 v77, v77, s68, v3
    v_and_or_b32 v78, v78, s68, v3
    v_and_or_b32 v79, v79, s68, v3
    s_add_u32 s63, s66, 264192
    buffer_store_dwordx4 v[76:79], v168, s[24:27], s63 offen sc1
    v_and_or_b32 v80, v80, s68, v3
    v_and_or_b32 v81, v81, s68, v3
    v_and_or_b32 v82, v82, s68, v3
    v_and_or_b32 v83, v83, s68, v3
    s_add_u32 s63, s66, 396288
    buffer_store_dwordx4 v[80:83], v168, s[24:27], s63 offen sc1
    v_and_or_b32 v92, v92, s68, v3
    v_and_or_b32 v93, v93, s68, v3
    v_and_or_b32 v94, v94, s68, v3
    v_and_or_b32 v95, v95, s68, v3
    s_add_u32 s63, s66, 792576
    buffer_store_dwordx4 v[92:95], v168, s[24:27], s63 offen sc1
    v_and_or_b32 v96, v96, s68, v3
    v_and_or_b32 v97, v97, s68, v3
    v_and_or_b32 v98, v98, s68, v3
    v_and_or_b32 v99, v99, s68, v3
    s_add_u32 s63, s66, 924672
    buffer_store_dwordx4 v[96:99], v168, s[24:27], s63 offen sc1
    v_and_or_b32 v100, v100, s68, v3
    v_and_or_b32 v101, v101, s68, v3
    v_and_or_b32 v102, v102, s68, v3
    v_and_or_b32 v103, v103, s68, v3
    s_add_u32 s63, s66, 1056768
    buffer_store_dwordx4 v[100:103], v168, s[24:27], s63 offen sc1
    s_nop 0
    s_branch L_fin
L_wo2:
    s_cmp_lg_u32 s58, 2
    s_cbranch_scc1 L_wo3
    v_and_or_b32 v68, v68, s68, v3
    v_and_or_b32 v69, v69, s68, v3
    v_and_or_b32 v70, v70, s68, v3
    v_and_or_b32 v71, v71, s68, v3
    s_add_u32 s63, s66, 0
    buffer_store_dwordx4 v[68:71], v168, s[24:27], s63 offen sc1
    v_and_or_b32 v72, v72, s68, v3
    v_and_or_b32 v73, v73, s68, v3
    v_and_or_b32 v74, v74, s68, v3
    v_and_or_b32 v75, v75, s68, v3
    s_add_u32 s63, s66, 132096
    buffer_store_dwordx4 v[72:75], v168, s[24:27], s63 offen sc1
    s_waitcnt lgkmcnt(3)
    v_mfma_f32_16x16x32_bf16 v[84:87], a[0:3], v[152:155], v[84:87]
    v_mfma_f32_16x16x32_bf16 v[88:91], a[16:19], v[152:155], v[88:91]
    s_waitcnt lgkmcnt(2)
    v_mfma_f32_16x16x32_bf16 v[84:87], a[4:7], v[156:159], v[84:87]
    v_mfma_f32_16x16x32_bf16 v[88:91], a[20:23], v[156:159], v[88:91]
    s_waitcnt lgkmcnt(1)
    v_mfma_f32_16x16x32_bf16 v[84:87], a[8:11], v[160:163], v[84:87]
    v_mfma_f32_16x16x32_bf16 v[88:91], a[24:27], v[160:163], v[88:91]
    s_waitcnt lgkmcnt(0)
    v_mfma_f32_16x16x32_bf16 v[84:87], a[12:15], v[164:167], v[84:87]
    v_mfma_f32_16x16x32_bf16 v[88:91], a[28:31], v[164:167], v[88:91]
    v_and_or_b32 v76, v76, s68, v3
    v_and_or_b32 v77, v77, s68, v3
    v_and_or_b32 v78, v78, s68, v3
    v_and_or_b32 v79, v79, s68, v3
    s_add_u32 s63, s66, 264192
    buffer_store_dwordx4 v[76:79], v168, s[24:27], s63 offen sc1
    v_and_or_b32 v80, v80, s68, v3
    v_and_or_b32 v81, v81, s68, v3
    v_and_or_b32 v82, v82, s68, v3
    v_and_or_b32 v83, v83, s68, v3
    s_add_u32 s63, s66, 396288
    buffer_store_dwordx4 v[80:83], v168, s[24:27], s63 offen sc1
    v_and_or_b32 v84, v84, s68, v3
    v_and_or_b32 v85, v85, s68, v3
    v_and_or_b32 v86, v86, s68, v3
    v_and_or_b32 v87, v87, s68, v3
    s_add_u32 s63, s66, 528384
    buffer_store_dwordx4 v[84:87], v168, s[24:27], s63 offen sc1
    v_and_or_b32 v88, v88, s68, v3
    v_and_or_b32 v89, v89, s68, v3
    v_and_or_b32 v90, v90, s68, v3
    v_and_or_b32 v91, v91, s68, v3
    s_add_u32 s63, s66, 660480
    buffer_store_dwordx4 v[88:91], v168, s[24:27], s63 offen sc1
    v_and_or_b32 v92, v92, s68, v3
    v_and_or_b32 v93, v93, s68, v3
    v_and_or_b32 v94, v94, s68, v3
    v_and_or_b32 v95, v95, s68, v3
    s_add_u32 s63, s66, 792576
    buffer_store_dwordx4 v[92:95], v168, s[24:27], s63 offen sc1
    v_and_or_b32 v96, v96, s68, v3
    v_and_or_b32 v97, v97, s68, v3
    v_and_or_b32 v98, v98, s68, v3
    v_and_or_b32 v99, v99, s68, v3
    s_add_u32 s63, s66, 924672
    buffer_store_dwordx4 v[96:99], v168, s[24:27], s63 offen sc1
    v_and_or_b32 v100, v100, s68, v3
    v_and_or_b32 v101, v101, s68, v3
    v_and_or_b32 v102, v102, s68, v3
    v_and_or_b32 v103, v103, s68, v3
    s_add_u32 s63, s66, 1056768
    buffer_store_dwordx4 v[100:103], v168, s[24:27], s63 offen sc1
    s_nop 0
    s_branch L_fin
L_wo3:
    v_and_or_b32 v68, v68, s68, v3
    v_and_or_b32 v69, v69, s68, v3
    v_and_or_b32 v70, v70, s68, v3
    v_and_or_b32 v71, v71, s68, v3
    s_add_u32 s63, s66, 0
    buffer_store_dwordx4 v[68:71], v168, s[24:27], s63 offen sc1
    v_and_or_b32 v72, v72, s68, v3
    v_and_or_b32 v73, v73, s68, v3
    v_and_or_b32 v74, v74, s68, v3
    v_and_or_b32 v75, v75, s68, v3
    s_add_u32 s63, s66, 132096
    buffer_store_dwordx4 v[72:75], v168, s[24:27], s63 offen sc1
    s_waitcnt lgkmcnt(3)
    v_mfma_f32_16x16x32_bf16 v[92:95], a[0:3], v[152:155], v[92:95]
    v_mfma_f32_16x16x32_bf16 v[96:99], a[16:19], v[152:155], v[96:99]
    v_mfma_f32_16x16x32_bf16 v[100:103], a[32:35], v[152:155], v[100:103]
    s_waitcnt lgkmcnt(2)
    v_mfma_f32_16x16x32_bf16 v[92:95], a[4:7], v[156:159], v[92:95]
    v_mfma_f32_16x16x32_bf16 v[96:99], a[20:23], v[156:159], v[96:99]
    v_mfma_f32_16x16x32_bf16 v[100:103], a[36:39], v[156:159], v[100:103]
    s_waitcnt lgkmcnt(1)
    v_mfma_f32_16x16x32_bf16 v[92:95], a[8:11], v[160:163], v[92:95]
    v_mfma_f32_16x16x32_bf16 v[96:99], a[24:27], v[160:163], v[96:99]
    v_mfma_f32_16x16x32_bf16 v[100:103], a[40:43], v[160:163], v[100:103]
    s_waitcnt lgkmcnt(0)
    v_mfma_f32_16x16x32_bf16 v[92:95], a[12:15], v[164:167], v[92:95]
    v_mfma_f32_16x16x32_bf16 v[96:99], a[28:31], v[164:167], v[96:99]
    v_mfma_f32_16x16x32_bf16 v[100:103], a[44:47], v[164:167], v[100:103]
    v_and_or_b32 v76, v76, s68, v3
    v_and_or_b32 v77, v77, s68, v3
    v_and_or_b32 v78, v78, s68, v3
    v_and_or_b32 v79, v79, s68, v3
    s_add_u32 s63, s66, 264192
    buffer_store_dwordx4 v[76:79], v168, s[24:27], s63 offen sc1
    v_and_or_b32 v80, v80, s68, v3
    v_and_or_b32 v81, v81, s68, v3
    v_and_or_b32 v82, v82, s68, v3
    v_and_or_b32 v83, v83, s68, v3
    s_add_u32 s63, s66, 396288
    buffer_store_dwordx4 v[80:83], v168, s[24:27], s63 offen sc1
    v_and_or_b32 v92, v92, s68, v3
    v_and_or_b32 v93, v93, s68, v3
    v_and_or_b32 v94, v94, s68, v3
    v_and_or_b32 v95, v95, s68, v3
    s_add_u32 s63, s66, 792576
    buffer_store_dwordx4 v[92:95], v168, s[24:27], s63 offen sc1
    v_and_or_b32 v96, v96, s68, v3
    v_and_or_b32 v97, v97, s68, v3
    v_and_or_b32 v98, v98, s68, v3
    v_and_or_b32 v99, v99, s68, v3
    s_add_u32 s63, s66, 924672
    buffer_store_dwordx4 v[96:99], v168, s[24:27], s63 offen sc1
    v_and_or_b32 v100, v100, s68, v3
    v_and_or_b32 v101, v101, s68, v3
    v_and_or_b32 v102, v102, s68, v3
    v_and_or_b32 v103, v103, s68, v3
    s_add_u32 s63, s66, 1056768
    buffer_store_dwordx4 v[100:103], v168, s[24:27], s63 offen sc1
    v_and_or_b32 v84, v84, s68, v3
    v_and_or_b32 v85, v85, s68, v3
    v_and_or_b32 v86, v86, s68, v3
    v_and_or_b32 v87, v87, s68, v3
    s_add_u32 s63, s66, 528384
    buffer_store_dwordx4 v[84:87], v168, s[24:27], s63 offen sc1
    v_and_or_b32 v88, v88, s68, v3
    v_and_or_b32 v89, v89, s68, v3
    v_and_or_b32 v90, v90, s68, v3
    v_and_or_b32 v91, v91, s68, v3
    s_add_u32 s63, s66, 660480
    buffer_store_dwordx4 v[88:91], v168, s[24:27], s63 offen sc1
L_fin:
L_end:
    s_endpgm
.section .rodata,"a"
.p2align 6
.amdhsa_kernel parallel_sum__compressed_kv_cla__glu_gated_swiglu__decode_kernel
  .amdhsa_next_free_vgpr 512
  .amdhsa_next_free_sgpr 102
  .amdhsa_accum_offset 256
  .amdhsa_group_segment_fixed_size 0
  .amdhsa_kernarg_size 104
  .amdhsa_user_sgpr_count 2
  .amdhsa_user_sgpr_kernarg_segment_ptr 1
  .amdhsa_system_sgpr_workgroup_id_x 1
  .amdhsa_float_denorm_mode_32 3
.end_amdhsa_kernel
```
